```python
import torch

def _softmax(x, axis=-1):
    return torch.softmax(x, dim=axis)
def _gelu(x):
    return torch.nn.functional.gelu(x, approximate="tanh")
def _silu(x):
    return torch.nn.functional.silu(x)
def _sigmoid(x):
    return torch.sigmoid(x)
def _layernorm(x, axis=-1, eps=1e-5):
    m = x.mean(dim=axis, keepdim=True)
    v = x.var(dim=axis, keepdim=True, unbiased=False)
    return (x - m) / torch.sqrt(v + eps)
def _scatter_add(tgt, idx, src, axis=0):
    return tgt.clone().index_add_(axis, idx, src)
def _segment_sum(src, seg, n):
    out = torch.zeros((n,) + src.shape[1:], dtype=src.dtype)
    return out.index_add_(0, seg, src)
def _pad(x, pw):
    flat = tuple(v for pair in reversed(pw) for v in pair)
    return torch.nn.functional.pad(x, flat)

kernel_name = 'parallel_sum__linear_attn_block__glu_gated_bilinear__prompt'

def setup_inputs():

    _w = (lambda a: (lambda t: t.to(torch.bfloat16) if t.is_floating_point() else t)(torch.as_tensor(a)))
    def _A_setup():
        B, S, D = 1, 2048, 512
        return {
            "x": _w((lambda *s: torch.randn(*s, dtype=torch.bfloat16) * 0.05)(B, S, D)),
            "wqkv": _w((lambda *s: torch.randn(*s, dtype=torch.bfloat16) * 0.05)(D, 3 * D)),
            "wo": _w((lambda *s: torch.randn(*s, dtype=torch.bfloat16) * 0.05)(D, D)),
        }
    _A_in = _A_setup()

    def _B_setup():
        B, S, D, F = 1, 2048, 512, 1792
        return {
            "x": _w((lambda *s: torch.randn(*s, dtype=torch.bfloat16) * 0.05)(B, S, D)),
            "w_gate": _w((lambda *s: torch.randn(*s, dtype=torch.bfloat16) * 0.2)(D, F) * (D ** -0.5)),
            "w_up": _w((lambda *s: torch.randn(*s, dtype=torch.bfloat16) * 0.2)(D, F) * (D ** -0.5)),
            "w_down": _w((lambda *s: torch.randn(*s, dtype=torch.bfloat16) * 0.2)(F, D) * (F ** -0.5)),
        }
    _B_in = _B_setup()

    return {
        "A_x": _A_in["x"],
        "A_wqkv": _A_in["wqkv"],
        "A_wo": _A_in["wo"],
        "B_x": _B_in["x"],
        "B_w_gate": _B_in["w_gate"],
        "B_w_up": _B_in["w_up"],
        "B_w_down": _B_in["w_down"],
    }

def reference(A_x, A_wqkv, A_wo, B_x, B_w_gate, B_w_up, B_w_down):
    def _A_ref(x, wqkv, wo):
        B, S, D = x.shape
        H = 32; Dh = D // H
        qkv = (lambda x, *d: x.permute(*d))((x @ wqkv).reshape(B, S, 3, H, Dh), 2, 0, 3, 1, 4)
        q, k, v = qkv[0], qkv[1], qkv[2]
        phi = lambda t: torch.where(t > 0, t + 1, torch.exp(t)) + 1e-6
        pq, pk = phi(q), phi(k)
        kv = torch.einsum("bhsd,bhse->bhde", pk, v)
        z = torch.einsum("bhsd->bhd", pk)
        num = torch.einsum("bhqd,bhde->bhqe", pq, kv)
        den = torch.einsum("bhqd,bhd->bhq", pq, z)[..., None] + 1e-6
        o = num / den
        return (lambda x, *d: x.permute(*d))(o, 0, 2, 1, 3).reshape(B, S, D) @ wo

    def _B_ref(x, w_gate, w_up, w_down):
        g = torch.einsum("bsd,df->bsf", x, w_gate)
        u = torch.einsum("bsd,df->bsf", x, w_up)
        h = g * u
        return torch.einsum("bsf,fd->bsd", h, w_down)

    x = A_x
    xn = _layernorm(x, axis=-1)
    return x + _A_ref(xn, A_wqkv, A_wo) + _B_ref(xn, B_w_gate, B_w_up, B_w_down)
```

```asm
; @launch grid=(256,1,1) block=(256,1,1) lds=163840
.amdgcn_target "amdgcn-amd-amdhsa--gfx950"
.text
.globl parallel_sum__linear_attn_block__glu_gated_bilinear__prompt_kernel
.p2align 8
.type parallel_sum__linear_attn_block__glu_gated_bilinear__prompt_kernel,@function
parallel_sum__linear_attn_block__glu_gated_bilinear__prompt_kernel:
  s_cmp_ge_u32 s2, 256
  s_cbranch_scc1 K12_end
  s_load_dwordx16 s[64:79], s[0:1], 0
  s_load_dwordx2 s[32:33], s[0:1], 72
  s_getpc_b64 s[62:63]
K12_pc:
  v_and_b32 v236, 63, v0
  v_lshrrev_b32 v240, 6, v0
  v_mov_b32 v238, v0
  v_lshlrev_b32 v237, 4, v236
  v_readfirstlane_b32 s34, v240
  s_and_b32 s54, s2, 7
  s_lshr_b32 s55, s2, 3
  s_lshl_b32 s56, s55, 2
  s_add_u32 s56, s56, s34
  s_min_u32 s56, s56, ((K12_end-K12_pc)>>10)-1
  s_lshl_b32 s56, s56, 10
  v_add_u32 v244, s56, v237
  global_load_dwordx4 v[196:199], v244, s[62:63]
  s_and_b32 s56, s55, 7
  s_lshr_b32 s82, s55, 3
  s_lshr_b32 s37, s54, 2
  s_lshl_b32 s37, s37, 3
  s_add_u32 s37, s37, s56
  s_and_b32 s38, s54, 3
  s_lshl_b32 s38, s38, 1
  s_and_b32 s57, s82, 1
  s_add_u32 s38, s38, s57
  s_and_b32 s83, s55, 3
  s_lshl_b32 s57, s54, 2
  s_add_u32 s83, s83, s57
  s_lshr_b32 s58, s55, 2
  s_add_u32 s54, s82, s56
  s_and_b32 s54, s54, 3
  s_lshl_b32 s54, s54, 1
  s_lshr_b32 s55, s56, 2
  s_add_u32 s54, s54, s55
  s_add_u32 s54, s82, s56
  s_and_b32 s54, s54, 7
  s_lshl_b32 s39, s54, 6
  s_lshr_b32 s35, s34, 1
  s_and_b32 s36, s34, 1
  v_lshrrev_b32 v240, 3, v236
  v_and_b32 v241, 7, v236
  v_lshrrev_b32 v243, 4, v236
  v_xor_b32 v243, v241, v243
  v_lshlrev_b32 v243, 4, v243
  v_lshlrev_b32 v244, 10, v240
  v_add_u32 v230, v243, v244
  v_xor_b32 v231, 64, v230
  v_add_u32 v231, 8192, v231
  v_add_u32 v232, 16384, v230
  v_add_u32 v233, 16384, v231
  s_lshl_b32 s47, s37, 7
  s_lshl_b32 s54, s34, 5
  s_add_u32 s47, s47, s54
  s_lshl_b32 s47, s47, 10
  s_lshl_b32 s44, s39, 1
  s_and_b32 s54, s34, 1
  s_lshl_b32 s54, s54, 4
  s_add_u32 s40, s39, s54
  s_lshl_b32 s54, s34, 3
  s_add_u32 s39, s39, s54
  s_lshl_b32 s45, s34, 10
  s_lshl_b32 s46, s34, 12
  s_lshr_b32 s54, s82, 1
  s_lshl_b32 s54, s54, 3
  s_add_u32 s57, s54, s38
  s_lshl_b32 s54, s37, 7
  s_lshl_b32 s55, s57, 3
  s_add_u32 s54, s54, s55
  s_lshl_b32 s55, s34, 1
  s_add_u32 s56, s54, s55
  s_lshl_b32 s54, s56, 10
  v_add_u32 v245, s54, v237
  s_waitcnt lgkmcnt(0)
  s_mov_b32 s70, s58
  s_cmp_ge_u32 s2, 18
  s_cbranch_scc1 K12_nozero
  s_lshl_b32 s54, s2, 12
  s_add_u32 s54, s54, 32768
  v_lshlrev_b32 v246, 4, v238
  v_add_u32 v246, s54, v246
  v_mov_b32 v248, 0
  v_mov_b32 v249, 0
  v_mov_b32 v250, 0
  v_mov_b32 v251, 0
  global_store_dwordx4 v246, v[248:251], s[32:33] sc1
K12_nozero:
  global_load_dwordx4 v[180:183], v245, s[64:65]
  global_load_dwordx4 v[184:187], v245, s[64:65] offset:1024
  s_lshl_b32 s80, s56, 2
  s_mov_b32 s81, s57
  s_mov_b32 s4, s64
  s_and_b32 s5, s65, 0xffff
  s_mov_b32 s6, 2097152
  s_mov_b32 s7, 0x20000
  s_cmp_ge_u32 s82, 2
  s_cbranch_scc1 K12_typeB
  s_add_u32 s59, s47, s44
  s_add_u32 m0, s46, 0
  s_nop 0
  buffer_load_dwordx4 v230, s[4:7], s59 offen lds
  s_add_u32 m0, s46, 1024
  s_nop 0
  buffer_load_dwordx4 v231, s[4:7], s59 offen lds
  s_add_u32 m0, s46, 2048
  s_nop 0
  buffer_load_dwordx4 v232, s[4:7], s59 offen lds
  s_add_u32 m0, s46, 3072
  s_nop 0
  buffer_load_dwordx4 v233, s[4:7], s59 offen lds
  s_lshr_b32 s54, s38, 1
  s_mul_i32 s54, s54, 7
  s_and_b32 s55, s38, 1
  s_lshl_b32 s55, s55, 1
  s_add_u32 s54, s54, s55
  s_lshl_b32 s54, s54, 7
  s_add_u32 s8, s72, s54
  s_addc_u32 s9, s73, 0
  s_and_b32 s9, s9, 0xffff
  s_sub_u32 s10, 1835008, s54
  s_mov_b32 s11, 0x20000
  s_add_u32 s12, s74, s54
  s_addc_u32 s13, s75, 0
  s_and_b32 s13, s13, 0xffff
  s_sub_u32 s14, 1835008, s54
  s_mov_b32 s15, 0x20000
  s_add_u32 s54, s54, 128
  s_add_u32 s16, s72, s54
  s_addc_u32 s17, s73, 0
  s_and_b32 s17, s17, 0xffff
  s_sub_u32 s18, 1835008, s54
  s_mov_b32 s19, 0x20000
  s_add_u32 s20, s74, s54
  s_addc_u32 s21, s75, 0
  s_and_b32 s21, s21, 0xffff
  s_sub_u32 s22, 1835008, s54
  s_mov_b32 s23, 0x20000
  s_lshl_b32 s54, s38, 7
  s_add_u32 s24, s66, s54
  s_addc_u32 s25, s67, 0
  s_and_b32 s25, s25, 0xffff
  s_sub_u32 s26, 1572864, s54
  s_mov_b32 s27, 0x20000
  v_lshrrev_b32 v240, 3, v236
  v_and_b32 v241, 7, v236
  v_lshrrev_b32 v242, 4, v236
  v_and_b32 v242, 1, v242
  v_lshlrev_b32 v243, 1, v242
  v_xor_b32 v243, v241, v243
  v_lshlrev_b32 v243, 4, v243
  v_mul_u32_u24 v244, 3584, v240
  v_add_u32 v225, v243, v244
  v_lshlrev_b32 v243, 1, v242
  v_or_b32 v243, 4, v243
  v_xor_b32 v243, v241, v243
  v_lshlrev_b32 v243, 4, v243
  v_mul_u32_u24 v244, 3584, v240
  v_add_u32 v226, v243, v244
  v_lshlrev_b32 v243, 2, v242
  v_xor_b32 v243, v241, v243
  v_lshlrev_b32 v243, 4, v243
  v_mul_u32_u24 v244, 3072, v240
  v_add_u32 v229, v243, v244
  s_mul_i32 s41, s39, 3072
  s_mul_i32 s42, s39, 3584
  s_add_u32 m0, s45, 49152
  s_nop 0
  buffer_load_dwordx4 v225, s[8:11], s42 offen lds
  s_add_u32 m0, s45, 53248
  s_nop 0
  buffer_load_dwordx4 v226, s[12:15], s42 offen lds
  s_add_u32 m0, s45, 57344
  s_nop 0
  buffer_load_dwordx4 v225, s[16:19], s42 offen lds
  s_add_u32 m0, s45, 61440
  s_nop 0
  buffer_load_dwordx4 v226, s[20:23], s42 offen lds
  s_add_u32 m0, s45, 65536
  s_nop 0
  buffer_load_dwordx4 v229, s[24:27], s41 offen lds
  s_add_u32 s39, s39, 32
  s_and_b32 s39, s39, 511
  s_mul_i32 s41, s39, 3072
  s_mul_i32 s42, s39, 3584
  s_add_u32 m0, s45, 69632
  s_nop 0
  buffer_load_dwordx4 v225, s[8:11], s42 offen lds
  s_add_u32 m0, s45, 73728
  s_nop 0
  buffer_load_dwordx4 v226, s[12:15], s42 offen lds
  s_add_u32 m0, s45, 77824
  s_nop 0
  buffer_load_dwordx4 v225, s[16:19], s42 offen lds
  s_add_u32 m0, s45, 81920
  s_nop 0
  buffer_load_dwordx4 v226, s[20:23], s42 offen lds
  s_add_u32 m0, s45, 86016
  s_nop 0
  buffer_load_dwordx4 v229, s[24:27], s41 offen lds
  v_lshlrev_b32 v243, 2, v242
  v_xor_b32 v243, v241, v243
  v_lshlrev_b32 v243, 4, v243
  v_lshlrev_b32 v244, 10, v240
  v_add_u32 v239, v243, v244
  v_add_u32 v227, 8192, v239
  s_lshl_b32 s54, s70, 7
  s_mul_i32 s55, s34, 458752
  s_add_u32 s54, s54, s55
  s_add_u32 s48, s76, s54
  s_addc_u32 s49, s77, 0
  s_and_b32 s49, s49, 0xffff
  s_sub_u32 s50, 1835008, s54
  s_mov_b32 s51, 0x20000
  s_mul_i32 s52, s34, 12288
  s_add_u32 s52, s52, 110592
  s_lshr_b32 s54, s2, 3
  s_and_b32 s55, s54, 3
  s_mul_i32 s55, s55, 7
  s_lshr_b32 s54, s54, 2
  s_mul_i32 s54, s54, 3
  s_add_u32 s77, s54, s55
  s_cmp_ge_u32 s77, 28
  s_cselect_b32 s54, 28, 0
  s_sub_u32 s77, s77, s54
  s_lshl_b32 s75, s77, 14
  s_load_dwordx2 s[72:73], s[0:1], 64
  s_mov_b32 s67, s81
  s_lshr_b32 s54, s37, 3
  s_lshl_b32 s54, s54, 1
  s_add_u32 s66, s54, s35
  v_and_b32 v240, 31, v236
  v_and_b32 v241, 15, v240
  v_lshrrev_b32 v242, 4, v240
  s_lshr_b32 s54, s38, 1
  s_mul_i32 s54, s54, 7
  s_and_b32 s55, s38, 1
  s_lshl_b32 s55, s55, 1
  s_add_u32 s54, s54, s55
  s_add_u32 s54, s54, s36
  s_lshl_b32 s54, s54, 6
  s_add_u32 s54, s54, 1536
  v_mul_u32_u24 v243, 1792, v242
  v_add_u32 v243, v243, v241
  v_add_u32 v243, s54, v243
  v_lshlrev_b32 v243, 2, v243
  v_add_u32 v251, 79872, v243
  s_lshl_b32 s54, s38, 6
  s_lshl_b32 s55, s36, 5
  s_add_u32 s54, s54, s55
  v_mov_b32 v243, v240
  v_add_u32 v243, s54, v243
  v_lshlrev_b32 v243, 2, v243
  v_add_u32 v252, 79872, v243
  v_mov_b32 v243, 0x3f803f80
  v_accvgpr_write_b32 a220, v243
  v_accvgpr_write_b32 a221, v243
  v_accvgpr_write_b32 a222, v243
  v_accvgpr_write_b32 a223, v243
  s_add_u32 s28, s32, 131072
  s_addc_u32 s29, s33, 0
  s_and_b32 s29, s29, 0xffff
  s_mov_b32 s30, 9437184
  s_mov_b32 s31, 0x20000
  v_lshrrev_b32 v240, 4, v236
  v_and_b32 v240, 1, v240
  v_lshrrev_b32 v241, 5, v236
  v_and_b32 v242, 15, v236
  v_lshrrev_b32 v242, 2, v242
  v_and_b32 v243, 3, v236
  v_lshlrev_b32 v244, 3, v241
  v_add_u32 v244, v244, v242
  v_lshrrev_b32 v245, 1, v242
  v_and_b32 v245, 1, v245
  v_mov_b32 v246, 0
  v_lshlrev_b32 v246, 1, v246
  v_lshrrev_b32 v247, 1, v243
  v_add_u32 v246, v246, v247
  v_lshlrev_b32 v247, 1, v245
  v_lshlrev_b32 v216, 2, v240
  v_or_b32 v247, v247, v216
  v_xor_b32 v246, v246, v247
  v_lshlrev_b32 v246, 4, v246
  v_lshlrev_b32 v247, 7, v244
  v_add_u32 v246, v246, v247
  s_lshl_b32 s54, s36, 13
  s_add_u32 s54, s54, 49152
  v_lshlrev_b32 v247, 12, v240
  v_add_u32 v246, v246, v247
  v_add_u32 v246, s54, v246
  v_and_b32 v247, 1, v243
  v_lshlrev_b32 v247, 3, v247
  v_add_u32 v216, v246, v247
  v_xor_b32 v217, 32, v216
  v_xor_b32 v218, 64, v216
  v_xor_b32 v219, 96, v216
  s_lshl_b32 s54, s36, 1
  v_add_u32 v246, s54, v240
  v_lshlrev_b32 v246, 1, v246
  v_lshrrev_b32 v247, 1, v243
  v_add_u32 v246, v246, v247
  v_lshlrev_b32 v247, 2, v245
  v_xor_b32 v246, v246, v247
  v_lshlrev_b32 v246, 4, v246
  v_lshlrev_b32 v247, 7, v244
  v_add_u32 v246, v246, v247
  v_add_u32 v246, 65536, v246
  v_and_b32 v247, 1, v243
  v_lshlrev_b32 v247, 3, v247
  v_add_u32 v220, v246, v247
  v_lshlrev_b32 v246, 2, v241
  v_add_u32 v246, v246, v242
  v_lshlrev_b32 v246, 7, v246
  v_lshlrev_b32 v247, 1, v240
  v_lshrrev_b32 v254, 1, v243
  v_add_u32 v247, v247, v254
  v_lshlrev_b32 v254, 2, v245
  v_xor_b32 v247, v247, v254
  v_lshlrev_b32 v247, 4, v247
  v_add_u32 v246, v246, v247
  v_and_b32 v247, 1, v243
  v_lshlrev_b32 v247, 3, v247
  v_add_u32 v246, v246, v247
  v_add_u32 v254, s52, v246
  v_xor_b32 v255, 64, v254
  v_and_b32 v246, 31, v236
  s_lshl_b32 s54, s35, 6
  v_add_u32 v246, s54, v246
  v_lshrrev_b32 v247, 1, v246
  v_and_b32 v247, 7, v247
  v_xor_b32 v247, v247, v241
  v_lshlrev_b32 v247, 4, v247
  v_lshlrev_b32 v246, 7, v246
  v_add_u32 v246, v246, v247
  v_xor_b32 v221, 0, v246
  v_xor_b32 v222, 32, v246
  v_xor_b32 v223, 64, v246
  v_xor_b32 v224, 96, v246
  s_add_u32 s44, s44, 128
  s_and_b32 s44, s44, 1023
  s_add_u32 s59, s47, s44
  s_add_u32 m0, s46, 16384
  s_nop 0
  buffer_load_dwordx4 v230, s[4:7], s59 offen lds
  s_add_u32 m0, s46, 17408
  s_nop 0
  buffer_load_dwordx4 v231, s[4:7], s59 offen lds
  s_add_u32 m0, s46, 18432
  s_nop 0
  buffer_load_dwordx4 v232, s[4:7], s59 offen lds
  s_add_u32 m0, s46, 19456
  s_nop 0
  buffer_load_dwordx4 v233, s[4:7], s59 offen lds
  s_waitcnt vmcnt(18)
  v_lshlrev_b32 v248, 16, v180
  v_and_b32 v249, 0xffff0000, v180
  v_pk_mul_f32 v[244:245], v[248:249], v[248:249]
  v_mov_b32 v240, v248
  v_mov_b32 v241, v249
  v_lshlrev_b32 v248, 16, v181
  v_and_b32 v249, 0xffff0000, v181
  v_pk_add_f32 v[240:241], v[240:241], v[248:249]
  v_pk_fma_f32 v[244:245], v[248:249], v[248:249], v[244:245]
  v_lshlrev_b32 v248, 16, v182
  v_and_b32 v249, 0xffff0000, v182
  v_pk_add_f32 v[240:241], v[240:241], v[248:249]
  v_pk_fma_f32 v[244:245], v[248:249], v[248:249], v[244:245]
  v_lshlrev_b32 v248, 16, v183
  v_and_b32 v249, 0xffff0000, v183
  v_pk_add_f32 v[240:241], v[240:241], v[248:249]
  v_pk_fma_f32 v[244:245], v[248:249], v[248:249], v[244:245]
  v_lshlrev_b32 v248, 16, v184
  v_and_b32 v249, 0xffff0000, v184
  v_pk_mul_f32 v[246:247], v[248:249], v[248:249]
  v_mov_b32 v242, v248
  v_mov_b32 v243, v249
  v_lshlrev_b32 v248, 16, v185
  v_and_b32 v249, 0xffff0000, v185
  v_pk_add_f32 v[242:243], v[242:243], v[248:249]
  v_pk_fma_f32 v[246:247], v[248:249], v[248:249], v[246:247]
  v_lshlrev_b32 v248, 16, v186
  v_and_b32 v249, 0xffff0000, v186
  v_pk_add_f32 v[242:243], v[242:243], v[248:249]
  v_pk_fma_f32 v[246:247], v[248:249], v[248:249], v[246:247]
  v_lshlrev_b32 v248, 16, v187
  v_and_b32 v249, 0xffff0000, v187
  v_pk_add_f32 v[242:243], v[242:243], v[248:249]
  v_pk_fma_f32 v[246:247], v[248:249], v[248:249], v[246:247]
  v_add_f32 v240, v240, v241
  v_add_f32 v242, v242, v243
  v_add_f32 v244, v244, v245
  v_add_f32 v246, v246, v247
  v_add_f32_dpp v240, v240, v240 row_shr:1 row_mask:0xf bank_mask:0xf
  v_add_f32_dpp v242, v242, v242 row_shr:1 row_mask:0xf bank_mask:0xf
  v_add_f32_dpp v244, v244, v244 row_shr:1 row_mask:0xf bank_mask:0xf
  v_add_f32_dpp v246, v246, v246 row_shr:1 row_mask:0xf bank_mask:0xf
  v_add_f32_dpp v240, v240, v240 row_shr:2 row_mask:0xf bank_mask:0xf
  v_add_f32_dpp v242, v242, v242 row_shr:2 row_mask:0xf bank_mask:0xf
  v_add_f32_dpp v244, v244, v244 row_shr:2 row_mask:0xf bank_mask:0xf
  v_add_f32_dpp v246, v246, v246 row_shr:2 row_mask:0xf bank_mask:0xf
  v_add_f32_dpp v240, v240, v240 row_shr:4 row_mask:0xf bank_mask:0xf
  v_add_f32_dpp v242, v242, v242 row_shr:4 row_mask:0xf bank_mask:0xf
  v_add_f32_dpp v244, v244, v244 row_shr:4 row_mask:0xf bank_mask:0xf
  v_add_f32_dpp v246, v246, v246 row_shr:4 row_mask:0xf bank_mask:0xf
  v_add_f32_dpp v240, v240, v240 row_shr:8 row_mask:0xf bank_mask:0xf
  v_add_f32_dpp v242, v242, v242 row_shr:8 row_mask:0xf bank_mask:0xf
  v_add_f32_dpp v244, v244, v244 row_shr:8 row_mask:0xf bank_mask:0xf
  v_add_f32_dpp v246, v246, v246 row_shr:8 row_mask:0xf bank_mask:0xf
  v_add_f32_dpp v240, v240, v240 row_bcast:15 row_mask:0xa bank_mask:0xf
  v_add_f32_dpp v242, v242, v242 row_bcast:15 row_mask:0xa bank_mask:0xf
  v_add_f32_dpp v244, v244, v244 row_bcast:15 row_mask:0xa bank_mask:0xf
  v_add_f32_dpp v246, v246, v246 row_bcast:15 row_mask:0xa bank_mask:0xf
  v_add_f32_dpp v240, v240, v240 row_bcast:31 row_mask:0xc bank_mask:0xf
  v_add_f32_dpp v242, v242, v242 row_bcast:31 row_mask:0xc bank_mask:0xf
  v_add_f32_dpp v244, v244, v244 row_bcast:31 row_mask:0xc bank_mask:0xf
  v_add_f32_dpp v246, v246, v246 row_bcast:31 row_mask:0xc bank_mask:0xf
  v_mul_f32 v240, 0x3b000000, v240
  v_mul_f32 v241, 0x3b000000, v242
  v_mul_f32 v244, 0x3b000000, v244
  v_mul_f32 v245, 0x3b000000, v246
  v_fma_f32 v244, -v240, v240, v244
  v_max_f32 v244, 0, v244
  v_add_f32 v244, 0x3727c5ac, v244
  v_rsq_f32 v244, v244
  v_fma_f32 v245, -v241, v241, v245
  v_max_f32 v245, 0, v245
  v_add_f32 v245, 0x3727c5ac, v245
  v_rsq_f32 v245, v245
  v_mov_b32 v248, s80
  v_add_u32 v249, 8192, v248
  s_mov_b64 s[60:61], exec
  s_mov_b32 exec_lo, 0
  s_mov_b32 exec_hi, 0x80000000
  global_store_dwordx2 v248, v[240:241], s[32:33] sc1
  global_store_dwordx2 v249, v[244:245], s[32:33] sc1
  s_mov_b64 exec, s[60:61]
  s_waitcnt lgkmcnt(0)
  s_waitcnt vmcnt(11)
  s_barrier
  ds_read_b128 v[200:203], v221 offset:0
  ds_read_b128 v[204:207], v221 offset:4096
  ds_read_b64_tr_b16 v[160:161], v216 offset:0
  ds_read_b64_tr_b16 v[162:163], v216 offset:512
  ds_read_b64_tr_b16 v[164:165], v217 offset:0
  ds_read_b64_tr_b16 v[166:167], v217 offset:512
  ds_read_b64_tr_b16 v[168:169], v218 offset:0
  ds_read_b64_tr_b16 v[170:171], v218 offset:512
  ds_read_b64_tr_b16 v[172:173], v219 offset:0
  ds_read_b64_tr_b16 v[174:175], v219 offset:512
  ds_read_b64_tr_b16 v[176:177], v220 offset:0
  ds_read_b64_tr_b16 v[178:179], v220 offset:512
  s_cmp_lt_u32 s2, 18
  s_cbranch_scc0 K12A_sig_init
  s_cmp_eq_u32 s34, 0
  s_cbranch_scc0 K12A_sig_init
  v_mov_b32 v249, 0
  v_mov_b32 v248, 1
  s_mov_b64 s[60:61], exec
  s_mov_b64 exec, 1
  global_atomic_add v249, v248, s[72:73] sc1
  s_mov_b64 exec, s[60:61]
K12A_sig_init:
  s_waitcnt lgkmcnt(0)
  v_mfma_f32_32x32x16_bf16 v[0:15], v[160:163], v[200:203], 0
  ds_read_b128 v[208:211], v222 offset:0
  ds_read_b128 v[212:215], v222 offset:4096
  s_add_u32 s39, s39, 32
  s_and_b32 s39, s39, 511
  v_mfma_f32_32x32x16_bf16 v[16:31], v[160:163], v[204:207], 0
  ds_read_b64_tr_b16 v[180:181], v216 offset:2048
  ds_read_b64_tr_b16 v[182:183], v216 offset:2560
  s_mul_i32 s41, s39, 3072
  s_mul_i32 s42, s39, 3584
  v_mfma_f32_32x32x16_bf16 v[32:47], v[164:167], v[200:203], 0
  ds_read_b64_tr_b16 v[184:185], v217 offset:2048
  s_add_u32 m0, s45, 90112
  ds_read_b64_tr_b16 v[186:187], v217 offset:2560
  buffer_load_dwordx4 v225, s[8:11], s42 offen lds
  v_mfma_f32_32x32x16_bf16 v[48:63], v[164:167], v[204:207], 0
  ds_read_b64_tr_b16 v[188:189], v218 offset:2048
  s_add_u32 m0, s45, 94208
  ds_read_b64_tr_b16 v[190:191], v218 offset:2560
  buffer_load_dwordx4 v226, s[12:15], s42 offen lds
  v_mfma_f32_32x32x16_bf16 v[64:79], v[168:171], v[200:203], 0
  ds_read_b64_tr_b16 v[192:193], v219 offset:2048
  s_add_u32 m0, s45, 98304
  ds_read_b64_tr_b16 v[194:195], v219 offset:2560
  buffer_load_dwordx4 v225, s[16:19], s42 offen lds
  v_mfma_f32_32x32x16_bf16 v[80:95], v[168:171], v[204:207], 0
  ds_read_b64_tr_b16 v[196:197], v220 offset:2048
  s_add_u32 m0, s45, 102400
  ds_read_b64_tr_b16 v[198:199], v220 offset:2560
  buffer_load_dwordx4 v226, s[20:23], s42 offen lds
  v_mfma_f32_32x32x16_bf16 v[96:111], v[172:175], v[200:203], 0
  s_add_u32 m0, s45, 106496
  s_nop 0
  buffer_load_dwordx4 v229, s[24:27], s41 offen lds
  v_mfma_f32_32x32x16_bf16 v[112:127], v[172:175], v[204:207], 0
  v_mfma_f32_32x32x16_bf16 v[128:143], v[176:179], v[200:203], 0
  v_mfma_f32_32x32x16_bf16 v[144:159], v[176:179], v[204:207], 0
  s_cmp_eq_u32 s66, 0
  s_cbranch_scc0 K12A_nocs0
  v_mfma_f32_32x32x16_bf16 a[140:155], a[220:223], v[160:163], 0
  v_mfma_f32_32x32x16_bf16 a[156:171], a[220:223], v[164:167], 0
  v_mfma_f32_32x32x16_bf16 a[172:187], a[220:223], v[168:171], 0
  v_mfma_f32_32x32x16_bf16 a[188:203], a[220:223], v[172:175], 0
  v_mfma_f32_32x32x16_bf16 a[204:219], a[220:223], v[176:179], 0
K12A_nocs0:
  s_waitcnt lgkmcnt(0)
  v_mfma_f32_32x32x16_bf16 v[0:15], v[180:183], v[208:211], v[0:15]
  s_waitcnt vmcnt(11)
  s_barrier
  s_add_u32 m0, s52, 0
  s_nop 0
  buffer_load_dwordx4 v239, s[48:51], s75 offen lds
  v_mfma_f32_32x32x16_bf16 v[16:31], v[180:183], v[212:215], v[16:31]
  ds_read_b128 v[200:203], v223 offset:0
  ds_read_b128 v[204:207], v223 offset:4096
  s_add_u32 s44, s44, 128
  s_and_b32 s44, s44, 1023
  s_add_u32 s59, s47, s44
  v_mfma_f32_32x32x16_bf16 v[32:47], v[184:187], v[208:211], v[32:47]
  ds_read_b64_tr_b16 v[160:161], v216 offset:20480
  s_add_u32 m0, s46, 32768
  ds_read_b64_tr_b16 v[162:163], v216 offset:20992
  buffer_load_dwordx4 v230, s[4:7], s59 offen lds
  v_mfma_f32_32x32x16_bf16 v[48:63], v[184:187], v[212:215], v[48:63]
  ds_read_b64_tr_b16 v[164:165], v217 offset:20480
  s_add_u32 m0, s46, 33792
  ds_read_b64_tr_b16 v[166:167], v217 offset:20992
  buffer_load_dwordx4 v231, s[4:7], s59 offen lds
  v_mfma_f32_32x32x16_bf16 v[64:79], v[188:191], v[208:211], v[64:79]
  ds_read_b64_tr_b16 v[168:169], v218 offset:20480
  s_add_u32 m0, s46, 34816
  ds_read_b64_tr_b16 v[170:171], v218 offset:20992
  buffer_load_dwordx4 v232, s[4:7], s59 offen lds
  v_mfma_f32_32x32x16_bf16 v[80:95], v[188:191], v[212:215], v[80:95]
  ds_read_b64_tr_b16 v[172:173], v219 offset:20480
  s_add_u32 m0, s46, 35840
  ds_read_b64_tr_b16 v[174:175], v219 offset:20992
  buffer_load_dwordx4 v233, s[4:7], s59 offen lds
  v_mfma_f32_32x32x16_bf16 v[96:111], v[192:195], v[208:211], v[96:111]
  ds_read_b64_tr_b16 v[176:177], v220 offset:20480
  ds_read_b64_tr_b16 v[178:179], v220 offset:20992
  s_add_u32 s39, s39, 32
  s_and_b32 s39, s39, 511
  v_mfma_f32_32x32x16_bf16 v[112:127], v[192:195], v[212:215], v[112:127]
  s_mul_i32 s41, s39, 3072
  s_mul_i32 s42, s39, 3584
  s_add_u32 m0, s45, 49152
  s_nop 0
  buffer_load_dwordx4 v225, s[8:11], s42 offen lds
  v_mfma_f32_32x32x16_bf16 v[128:143], v[196:199], v[208:211], v[128:143]
  s_add_u32 m0, s45, 53248
  s_nop 0
  buffer_load_dwordx4 v226, s[12:15], s42 offen lds
  s_add_u32 m0, s52, 1024
  s_nop 0
  buffer_load_dwordx4 v227, s[48:51], s75 offen lds
  v_mfma_f32_32x32x16_bf16 v[144:159], v[196:199], v[212:215], v[144:159]
  s_cmp_eq_u32 s66, 1
  s_cbranch_scc0 K12A_nocs1
  v_mfma_f32_32x32x16_bf16 a[140:155], a[220:223], v[180:183], 0
  v_mfma_f32_32x32x16_bf16 a[156:171], a[220:223], v[184:187], 0
  v_mfma_f32_32x32x16_bf16 a[172:187], a[220:223], v[188:191], 0
  v_mfma_f32_32x32x16_bf16 a[188:203], a[220:223], v[192:195], 0
  v_mfma_f32_32x32x16_bf16 a[204:219], a[220:223], v[196:199], 0
K12A_nocs1:
  s_waitcnt lgkmcnt(0)
  v_mfma_f32_32x32x16_bf16 v[0:15], v[160:163], v[200:203], v[0:15]
  ds_read_b128 v[208:211], v224 offset:0
  s_add_u32 m0, s45, 57344
  ds_read_b128 v[212:215], v224 offset:4096
  buffer_load_dwordx4 v225, s[16:19], s42 offen lds
  v_mfma_f32_32x32x16_bf16 v[16:31], v[160:163], v[204:207], v[16:31]
  ds_read_b64_tr_b16 v[180:181], v216 offset:22528
  s_add_u32 m0, s45, 61440
  ds_read_b64_tr_b16 v[182:183], v216 offset:23040
  buffer_load_dwordx4 v226, s[20:23], s42 offen lds
  v_mfma_f32_32x32x16_bf16 v[32:47], v[164:167], v[200:203], v[32:47]
  ds_read_b64_tr_b16 v[184:185], v217 offset:22528
  s_add_u32 m0, s45, 65536
  ds_read_b64_tr_b16 v[186:187], v217 offset:23040
  buffer_load_dwordx4 v229, s[24:27], s41 offen lds
  v_mfma_f32_32x32x16_bf16 v[48:63], v[164:167], v[204:207], v[48:63]
  ds_read_b64_tr_b16 v[188:189], v218 offset:22528
  ds_read_b64_tr_b16 v[190:191], v218 offset:23040
  s_add_u32 s75, s75, 16384
  s_cmp_eq_u32 s75, 458752
  s_cselect_b32 s75, 0, s75
  v_mfma_f32_32x32x16_bf16 v[64:79], v[168:171], v[200:203], v[64:79]
  ds_read_b64_tr_b16 v[192:193], v219 offset:22528
  s_add_u32 m0, s52, 2048
  ds_read_b64_tr_b16 v[194:195], v219 offset:23040
  buffer_load_dwordx4 v239, s[48:51], s75 offen lds
  v_mfma_f32_32x32x16_bf16 v[80:95], v[168:171], v[204:207], v[80:95]
  ds_read_b64_tr_b16 v[196:197], v220 offset:22528
  s_add_u32 m0, s52, 3072
  ds_read_b64_tr_b16 v[198:199], v220 offset:23040
  buffer_load_dwordx4 v227, s[48:51], s75 offen lds
  v_mfma_f32_32x32x16_bf16 v[96:111], v[172:175], v[200:203], v[96:111]
  s_add_u32 s75, s75, 16384
  s_cmp_eq_u32 s75, 458752
  s_cselect_b32 s75, 0, s75
  v_mfma_f32_32x32x16_bf16 v[112:127], v[172:175], v[204:207], v[112:127]
  v_mfma_f32_32x32x16_bf16 v[128:143], v[176:179], v[200:203], v[128:143]
  v_mfma_f32_32x32x16_bf16 v[144:159], v[176:179], v[204:207], v[144:159]
  s_cmp_eq_u32 s66, 2
  s_cbranch_scc0 K12A_nocs2
  v_mfma_f32_32x32x16_bf16 a[140:155], a[220:223], v[160:163], 0
  v_mfma_f32_32x32x16_bf16 a[156:171], a[220:223], v[164:167], 0
  v_mfma_f32_32x32x16_bf16 a[172:187], a[220:223], v[168:171], 0
  v_mfma_f32_32x32x16_bf16 a[188:203], a[220:223], v[172:175], 0
  v_mfma_f32_32x32x16_bf16 a[204:219], a[220:223], v[176:179], 0
K12A_nocs2:
  s_cmp_eq_u32 s34, 0
  s_cbranch_scc0 K12A_w0_initld
  v_mov_b32 v249, 0
  s_mov_b64 s[60:61], exec
  s_mov_b64 exec, 1
  global_load_dword v250, v249, s[72:73] sc1
  s_mov_b64 exec, s[60:61]
K12A_w0_initld:
  s_waitcnt lgkmcnt(0)
  v_mfma_f32_32x32x16_bf16 v[0:15], v[180:183], v[208:211], v[0:15]
  s_waitcnt vmcnt(13)
  s_barrier
  s_add_u32 m0, s52, 4096
  s_nop 0
  buffer_load_dwordx4 v239, s[48:51], s75 offen lds
  v_mfma_f32_32x32x16_bf16 v[16:31], v[180:183], v[212:215], v[16:31]
  ds_read_b128 v[200:203], v221 offset:16384
  ds_read_b128 v[204:207], v221 offset:20480
  s_add_u32 s39, s39, 32
  s_and_b32 s39, s39, 511
  v_mfma_f32_32x32x16_bf16 v[32:47], v[184:187], v[208:211], v[32:47]
  ds_read_b64_tr_b16 v[160:161], v216 offset:40960
  ds_read_b64_tr_b16 v[162:163], v216 offset:41472
  s_mul_i32 s41, s39, 3072
  s_mul_i32 s42, s39, 3584
  v_mfma_f32_32x32x16_bf16 v[48:63], v[184:187], v[212:215], v[48:63]
  ds_read_b64_tr_b16 v[164:165], v217 offset:40960
  s_add_u32 m0, s45, 69632
  ds_read_b64_tr_b16 v[166:167], v217 offset:41472
  buffer_load_dwordx4 v225, s[8:11], s42 offen lds
  v_mfma_f32_32x32x16_bf16 v[64:79], v[188:191], v[208:211], v[64:79]
  ds_read_b64_tr_b16 v[168:169], v218 offset:40960
  s_add_u32 m0, s45, 73728
  ds_read_b64_tr_b16 v[170:171], v218 offset:41472
  buffer_load_dwordx4 v226, s[12:15], s42 offen lds
  v_mfma_f32_32x32x16_bf16 v[80:95], v[188:191], v[212:215], v[80:95]
  ds_read_b64_tr_b16 v[172:173], v219 offset:40960
  s_add_u32 m0, s45, 77824
  ds_read_b64_tr_b16 v[174:175], v219 offset:41472
  buffer_load_dwordx4 v225, s[16:19], s42 offen lds
  v_mfma_f32_32x32x16_bf16 v[96:111], v[192:195], v[208:211], v[96:111]
  ds_read_b64_tr_b16 v[176:177], v220 offset:40960
  s_add_u32 m0, s45, 81920
  ds_read_b64_tr_b16 v[178:179], v220 offset:41472
  buffer_load_dwordx4 v226, s[20:23], s42 offen lds
  v_mfma_f32_32x32x16_bf16 v[112:127], v[192:195], v[212:215], v[112:127]
  s_add_u32 m0, s45, 86016
  s_nop 0
  buffer_load_dwordx4 v229, s[24:27], s41 offen lds
  s_add_u32 m0, s52, 5120
  s_nop 0
  buffer_load_dwordx4 v227, s[48:51], s75 offen lds
  v_mfma_f32_32x32x16_bf16 v[128:143], v[196:199], v[208:211], v[128:143]
  s_add_u32 s44, s44, 128
  s_and_b32 s44, s44, 1023
  s_add_u32 s59, s47, s44
  s_add_u32 m0, s46, 0
  s_nop 0
  buffer_load_dwordx4 v230, s[4:7], s59 offen lds
  v_mfma_f32_32x32x16_bf16 v[144:159], v[196:199], v[212:215], v[144:159]
  s_cmp_eq_u32 s66, 3
  s_cbranch_scc0 K12A_nocs3
  v_mfma_f32_32x32x16_bf16 a[140:155], a[220:223], v[180:183], 0
  v_mfma_f32_32x32x16_bf16 a[156:171], a[220:223], v[184:187], 0
  v_mfma_f32_32x32x16_bf16 a[172:187], a[220:223], v[188:191], 0
  v_mfma_f32_32x32x16_bf16 a[188:203], a[220:223], v[192:195], 0
  v_mfma_f32_32x32x16_bf16 a[204:219], a[220:223], v[196:199], 0
K12A_nocs3:
  s_waitcnt lgkmcnt(0)
  v_mfma_f32_32x32x16_bf16 v[0:15], v[160:163], v[200:203], v[0:15]
  ds_read_b128 v[208:211], v222 offset:16384
  s_add_u32 m0, s46, 1024
  ds_read_b128 v[212:215], v222 offset:20480
  buffer_load_dwordx4 v231, s[4:7], s59 offen lds
  v_mfma_f32_32x32x16_bf16 v[16:31], v[160:163], v[204:207], v[16:31]
  ds_read_b64_tr_b16 v[180:181], v216 offset:43008
  s_add_u32 m0, s46, 2048
  ds_read_b64_tr_b16 v[182:183], v216 offset:43520
  buffer_load_dwordx4 v232, s[4:7], s59 offen lds
  v_mfma_f32_32x32x16_bf16 v[32:47], v[164:167], v[200:203], v[32:47]
  ds_read_b64_tr_b16 v[184:185], v217 offset:43008
  s_add_u32 m0, s46, 3072
  ds_read_b64_tr_b16 v[186:187], v217 offset:43520
  buffer_load_dwordx4 v233, s[4:7], s59 offen lds
  v_mfma_f32_32x32x16_bf16 v[48:63], v[164:167], v[204:207], v[48:63]
  ds_read_b64_tr_b16 v[188:189], v218 offset:43008
  ds_read_b64_tr_b16 v[190:191], v218 offset:43520
  s_add_u32 s75, s75, 16384
  s_cmp_eq_u32 s75, 458752
  s_cselect_b32 s75, 0, s75
  v_mfma_f32_32x32x16_bf16 v[64:79], v[168:171], v[200:203], v[64:79]
  ds_read_b64_tr_b16 v[192:193], v219 offset:43008
  s_add_u32 m0, s52, 6144
  ds_read_b64_tr_b16 v[194:195], v219 offset:43520
  buffer_load_dwordx4 v239, s[48:51], s75 offen lds
  v_mfma_f32_32x32x16_bf16 v[80:95], v[168:171], v[204:207], v[80:95]
  ds_read_b64_tr_b16 v[196:197], v220 offset:43008
  s_add_u32 m0, s52, 7168
  ds_read_b64_tr_b16 v[198:199], v220 offset:43520
  buffer_load_dwordx4 v227, s[48:51], s75 offen lds
  v_mfma_f32_32x32x16_bf16 v[96:111], v[172:175], v[200:203], v[96:111]
  s_add_u32 s75, s75, 16384
  s_cmp_eq_u32 s75, 458752
  s_cselect_b32 s75, 0, s75
  v_mfma_f32_32x32x16_bf16 v[112:127], v[172:175], v[204:207], v[112:127]
  v_mfma_f32_32x32x16_bf16 v[128:143], v[176:179], v[200:203], v[128:143]
  v_mfma_f32_32x32x16_bf16 v[144:159], v[176:179], v[204:207], v[144:159]
  s_waitcnt lgkmcnt(0)
  v_mfma_f32_32x32x16_bf16 v[0:15], v[180:183], v[208:211], v[0:15]
  s_cmp_eq_u32 s34, 0
  s_cbranch_scc0 K12A_w0_initchk
  s_waitcnt vmcnt(13)
  v_readfirstlane_b32 s58, v250
  s_nop 0
  s_cmp_ge_u32 s58, 18
  s_cbranch_scc1 K12A_initok
  v_mov_b32 v249, 0
  s_mov_b32 s57, 0
K12A_spin_init:
  global_load_dword v250, v249, s[72:73] sc1
  s_waitcnt vmcnt(0)
  v_readfirstlane_b32 s58, v250
  s_add_u32 s57, s57, 1
  s_cmp_ge_u32 s57, 200000
  s_cbranch_scc1 K12A_spin_init_x
  s_cmp_ge_u32 s58, 18
  s_cbranch_scc1 K12A_spin_init_x
  s_sleep 2
  s_branch K12A_spin_init
K12A_spin_init_x:
K12A_initok:
K12A_w0_initchk:
  s_waitcnt vmcnt(15)
  s_barrier
  s_cmp_eq_u32 s34, 0
  s_cbranch_scc0 K12A_sig_st
  s_lshl_b32 s58, s37, 7
  s_add_u32 s58, s58, 100352
  v_mov_b32 v249, s58
  v_mov_b32 v248, 1
  s_mov_b64 s[60:61], exec
  s_mov_b64 exec, 1
  global_atomic_add v249, v248, s[32:33] sc1
  s_mov_b64 exec, s[60:61]
K12A_sig_st:
  v_mfma_f32_32x32x16_bf16 v[16:31], v[180:183], v[212:215], v[16:31]
  ds_read_b128 v[200:203], v223 offset:16384
  ds_read_b128 v[204:207], v223 offset:20480
  s_add_u32 s39, s39, 32
  s_and_b32 s39, s39, 511
  v_mfma_f32_32x32x16_bf16 v[32:47], v[184:187], v[208:211], v[32:47]
  ds_read_b64_tr_b16 v[160:161], v216 offset:0
  ds_read_b64_tr_b16 v[162:163], v216 offset:512
  s_mul_i32 s41, s39, 3072
  s_mul_i32 s42, s39, 3584
  v_mfma_f32_32x32x16_bf16 v[48:63], v[184:187], v[212:215], v[48:63]
  ds_read_b64_tr_b16 v[164:165], v217 offset:0
  s_add_u32 m0, s45, 90112
  ds_read_b64_tr_b16 v[166:167], v217 offset:512
  buffer_load_dwordx4 v225, s[8:11], s42 offen lds
  v_mfma_f32_32x32x16_bf16 v[64:79], v[188:191], v[208:211], v[64:79]
  ds_read_b64_tr_b16 v[168:169], v218 offset:0
  s_add_u32 m0, s45, 94208
  ds_read_b64_tr_b16 v[170:171], v218 offset:512
  buffer_load_dwordx4 v226, s[12:15], s42 offen lds
  v_mfma_f32_32x32x16_bf16 v[80:95], v[188:191], v[212:215], v[80:95]
  ds_read_b64_tr_b16 v[172:173], v219 offset:0
  s_add_u32 m0, s45, 98304
  ds_read_b64_tr_b16 v[174:175], v219 offset:512
  buffer_load_dwordx4 v225, s[16:19], s42 offen lds
  v_mfma_f32_32x32x16_bf16 v[96:111], v[192:195], v[208:211], v[96:111]
  ds_read_b64_tr_b16 v[176:177], v220 offset:0
  s_add_u32 m0, s45, 102400
  ds_read_b64_tr_b16 v[178:179], v220 offset:512
  buffer_load_dwordx4 v226, s[20:23], s42 offen lds
  v_mfma_f32_32x32x16_bf16 v[112:127], v[192:195], v[212:215], v[112:127]
  s_add_u32 m0, s45, 106496
  s_nop 0
  buffer_load_dwordx4 v229, s[24:27], s41 offen lds
  s_add_u32 m0, s52, 8192
  s_nop 0
  buffer_load_dwordx4 v239, s[48:51], s75 offen lds
  v_mfma_f32_32x32x16_bf16 v[128:143], v[196:199], v[208:211], v[128:143]
  s_add_u32 m0, s52, 9216
  s_nop 0
  buffer_load_dwordx4 v227, s[48:51], s75 offen lds
  v_mfma_f32_32x32x16_bf16 v[144:159], v[196:199], v[212:215], v[144:159]
  s_add_u32 s75, s75, 16384
  s_cmp_eq_u32 s75, 458752
  s_cselect_b32 s75, 0, s75
  s_waitcnt lgkmcnt(0)
  v_mfma_f32_32x32x16_bf16 v[0:15], v[160:163], v[200:203], v[0:15]
  ds_read_b128 v[208:211], v224 offset:16384
  ds_read_b128 v[212:215], v224 offset:20480
  v_accvgpr_read_b32 v240, a140
  v_accvgpr_read_b32 v241, a156
  v_accvgpr_read_b32 v242, a172
  v_mfma_f32_32x32x16_bf16 v[16:31], v[160:163], v[204:207], v[16:31]
  ds_read_b64_tr_b16 v[180:181], v216 offset:2048
  ds_read_b64_tr_b16 v[182:183], v216 offset:2560
  v_accvgpr_read_b32 v243, a188
  v_accvgpr_read_b32 v244, a204
  s_waitcnt vmcnt(25)
  v_mfma_f32_32x32x16_bf16 v[32:47], v[164:167], v[200:203], v[32:47]
  ds_read_b64_tr_b16 v[184:185], v217 offset:2048
  ds_read_b64_tr_b16 v[186:187], v217 offset:2560
  ds_read_b64_tr_b16 a[0:1], v254 offset:0
  ds_read_b64_tr_b16 a[2:3], v254 offset:1024
  v_mfma_f32_32x32x16_bf16 v[48:63], v[164:167], v[204:207], v[48:63]
  ds_read_b64_tr_b16 v[188:189], v218 offset:2048
  ds_read_b64_tr_b16 v[190:191], v218 offset:2560
  ds_read_b64_tr_b16 a[4:5], v255 offset:0
  ds_read_b64_tr_b16 a[6:7], v255 offset:1024
  v_mfma_f32_32x32x16_bf16 v[64:79], v[168:171], v[200:203], v[64:79]
  ds_read_b64_tr_b16 v[192:193], v219 offset:2048
  s_add_u32 m0, s52, 10240
  ds_read_b64_tr_b16 v[194:195], v219 offset:2560
  buffer_load_dwordx4 v239, s[48:51], s75 offen lds
  v_mfma_f32_32x32x16_bf16 v[80:95], v[168:171], v[204:207], v[80:95]
  ds_read_b64_tr_b16 v[196:197], v220 offset:2048
  s_add_u32 m0, s52, 11264
  ds_read_b64_tr_b16 v[198:199], v220 offset:2560
  buffer_load_dwordx4 v227, s[48:51], s75 offen lds
  v_mfma_f32_32x32x16_bf16 v[96:111], v[172:175], v[200:203], v[96:111]
  s_mov_b64 s[60:61], exec
  s_mov_b32 exec_hi, 0
  global_atomic_add_f32 v251, v240, s[32:33] offset:0
  global_atomic_add_f32 v251, v241, s[32:33] offset:64
  global_atomic_add_f32 v251, v242, s[32:33] offset:128
  global_atomic_add_f32 v251, v243, s[32:33] offset:192
  global_atomic_add_f32 v252, v244, s[32:33] offset:0
  s_mov_b64 exec, s[60:61]
  v_mfma_f32_32x32x16_bf16 v[112:127], v[172:175], v[204:207], v[112:127]
  s_add_u32 s75, s75, 16384
  s_cmp_eq_u32 s75, 458752
  s_cselect_b32 s75, 0, s75
  v_mfma_f32_32x32x16_bf16 v[128:143], v[176:179], v[200:203], v[128:143]
  v_mfma_f32_32x32x16_bf16 v[144:159], v[176:179], v[204:207], v[144:159]
  s_waitcnt lgkmcnt(0)
  v_mfma_f32_32x32x16_bf16 v[0:15], v[180:183], v[208:211], v[0:15]
  s_waitcnt vmcnt(21)
  s_barrier
  s_waitcnt vmcnt(27)
  ds_read_b64_tr_b16 a[8:9], v254 offset:2048
  ds_read_b64_tr_b16 a[10:11], v254 offset:3072
  v_mfma_f32_32x32x16_bf16 v[16:31], v[180:183], v[212:215], v[16:31]
  ds_read_b128 v[200:203], v221 offset:32768
  ds_read_b128 v[204:207], v221 offset:36864
  s_add_u32 s39, s39, 32
  s_and_b32 s39, s39, 511
  v_mfma_f32_32x32x16_bf16 v[32:47], v[184:187], v[208:211], v[32:47]
  ds_read_b64_tr_b16 v[160:161], v216 offset:20480
  ds_read_b64_tr_b16 v[162:163], v216 offset:20992
  s_mul_i32 s41, s39, 3072
  s_mul_i32 s42, s39, 3584
  v_mfma_f32_32x32x16_bf16 v[48:63], v[184:187], v[212:215], v[48:63]
  ds_read_b64_tr_b16 v[164:165], v217 offset:20480
  s_add_u32 m0, s45, 49152
  ds_read_b64_tr_b16 v[166:167], v217 offset:20992
  buffer_load_dwordx4 v225, s[8:11], s42 offen lds
  v_mfma_f32_32x32x16_bf16 v[64:79], v[188:191], v[208:211], v[64:79]
  ds_read_b64_tr_b16 v[168:169], v218 offset:20480
  s_add_u32 m0, s45, 53248
  ds_read_b64_tr_b16 v[170:171], v218 offset:20992
  buffer_load_dwordx4 v226, s[12:15], s42 offen lds
  v_mfma_f32_32x32x16_bf16 v[80:95], v[188:191], v[212:215], v[80:95]
  ds_read_b64_tr_b16 v[172:173], v219 offset:20480
  s_add_u32 m0, s45, 57344
  ds_read_b64_tr_b16 v[174:175], v219 offset:20992
  buffer_load_dwordx4 v225, s[16:19], s42 offen lds
  v_mfma_f32_32x32x16_bf16 v[96:111], v[192:195], v[208:211], v[96:111]
  ds_read_b64_tr_b16 v[176:177], v220 offset:20480
  s_add_u32 m0, s45, 61440
  ds_read_b64_tr_b16 v[178:179], v220 offset:20992
  buffer_load_dwordx4 v226, s[20:23], s42 offen lds
  v_mfma_f32_32x32x16_bf16 v[112:127], v[192:195], v[212:215], v[112:127]
  s_add_u32 m0, s45, 65536
  s_nop 0
  buffer_load_dwordx4 v229, s[24:27], s41 offen lds
  ds_read_b64_tr_b16 a[12:13], v255 offset:2048
  ds_read_b64_tr_b16 a[14:15], v255 offset:3072
  v_mfma_f32_32x32x16_bf16 v[128:143], v[196:199], v[208:211], v[128:143]
  s_add_u32 s44, s44, 128
  s_and_b32 s44, s44, 1023
  s_add_u32 s59, s47, s44
  s_add_u32 m0, s46, 16384
  s_nop 0
  buffer_load_dwordx4 v230, s[4:7], s59 offen lds
  v_mfma_f32_32x32x16_bf16 v[144:159], v[196:199], v[212:215], v[144:159]
  s_add_u32 m0, s46, 17408
  s_nop 0
  buffer_load_dwordx4 v231, s[4:7], s59 offen lds
  s_add_u32 m0, s52, 0
  s_nop 0
  buffer_load_dwordx4 v239, s[48:51], s75 offen lds
  s_waitcnt lgkmcnt(0)
  v_mfma_f32_32x32x16_bf16 v[0:15], v[160:163], v[200:203], v[0:15]
  ds_read_b128 v[208:211], v222 offset:32768
  s_add_u32 m0, s46, 18432
  ds_read_b128 v[212:215], v222 offset:36864
  buffer_load_dwordx4 v232, s[4:7], s59 offen lds
  v_mfma_f32_32x32x16_bf16 v[16:31], v[160:163], v[204:207], v[16:31]
  ds_read_b64_tr_b16 v[180:181], v216 offset:22528
  s_add_u32 m0, s46, 19456
  ds_read_b64_tr_b16 v[182:183], v216 offset:23040
  buffer_load_dwordx4 v233, s[4:7], s59 offen lds
  v_mfma_f32_32x32x16_bf16 v[32:47], v[164:167], v[200:203], v[32:47]
  ds_read_b64_tr_b16 v[184:185], v217 offset:22528
  s_add_u32 m0, s52, 1024
  ds_read_b64_tr_b16 v[186:187], v217 offset:23040
  buffer_load_dwordx4 v227, s[48:51], s75 offen lds
  v_mfma_f32_32x32x16_bf16 v[48:63], v[164:167], v[204:207], v[48:63]
  ds_read_b64_tr_b16 v[188:189], v218 offset:22528
  ds_read_b64_tr_b16 v[190:191], v218 offset:23040
  s_add_u32 s75, s75, 16384
  s_cmp_eq_u32 s75, 458752
  s_cselect_b32 s75, 0, s75
  v_mfma_f32_32x32x16_bf16 v[64:79], v[168:171], v[200:203], v[64:79]
  ds_read_b64_tr_b16 v[192:193], v219 offset:22528
  ds_read_b64_tr_b16 v[194:195], v219 offset:23040
  s_waitcnt vmcnt(31)
  ds_read_b64_tr_b16 a[16:17], v254 offset:4096
  ds_read_b64_tr_b16 a[18:19], v254 offset:5120
  v_mfma_f32_32x32x16_bf16 v[80:95], v[168:171], v[204:207], v[80:95]
  ds_read_b64_tr_b16 v[196:197], v220 offset:22528
  ds_read_b64_tr_b16 v[198:199], v220 offset:23040
  ds_read_b64_tr_b16 a[20:21], v255 offset:4096
  ds_read_b64_tr_b16 a[22:23], v255 offset:5120
  v_mfma_f32_32x32x16_bf16 v[96:111], v[172:175], v[200:203], v[96:111]
  s_add_u32 m0, s52, 2048
  s_nop 0
  buffer_load_dwordx4 v239, s[48:51], s75 offen lds
  v_mfma_f32_32x32x16_bf16 v[112:127], v[172:175], v[204:207], v[112:127]
  s_add_u32 m0, s52, 3072
  s_nop 0
  buffer_load_dwordx4 v227, s[48:51], s75 offen lds
  v_mfma_f32_32x32x16_bf16 v[128:143], v[176:179], v[200:203], v[128:143]
  s_add_u32 s75, s75, 16384
  s_cmp_eq_u32 s75, 458752
  s_cselect_b32 s75, 0, s75
  v_mfma_f32_32x32x16_bf16 v[144:159], v[176:179], v[204:207], v[144:159]
  s_waitcnt lgkmcnt(0)
  v_mfma_f32_32x32x16_bf16 v[0:15], v[180:183], v[208:211], v[0:15]
  s_waitcnt vmcnt(22)
  s_barrier
  s_waitcnt vmcnt(27)
  ds_read_b64_tr_b16 a[24:25], v254 offset:6144
  ds_read_b64_tr_b16 a[26:27], v254 offset:7168
  v_mfma_f32_32x32x16_bf16 v[16:31], v[180:183], v[212:215], v[16:31]
  ds_read_b128 v[200:203], v223 offset:32768
  ds_read_b128 v[204:207], v223 offset:36864
  s_add_u32 s39, s39, 32
  s_and_b32 s39, s39, 511
  v_mfma_f32_32x32x16_bf16 v[32:47], v[184:187], v[208:211], v[32:47]
  ds_read_b64_tr_b16 v[160:161], v216 offset:40960
  ds_read_b64_tr_b16 v[162:163], v216 offset:41472
  s_mul_i32 s41, s39, 3072
  s_mul_i32 s42, s39, 3584
  v_mfma_f32_32x32x16_bf16 v[48:63], v[184:187], v[212:215], v[48:63]
  ds_read_b64_tr_b16 v[164:165], v217 offset:40960
  s_add_u32 m0, s45, 69632
  ds_read_b64_tr_b16 v[166:167], v217 offset:41472
  buffer_load_dwordx4 v225, s[8:11], s42 offen lds
  v_mfma_f32_32x32x16_bf16 v[64:79], v[188:191], v[208:211], v[64:79]
  ds_read_b64_tr_b16 v[168:169], v218 offset:40960
  s_add_u32 m0, s45, 73728
  ds_read_b64_tr_b16 v[170:171], v218 offset:41472
  buffer_load_dwordx4 v226, s[12:15], s42 offen lds
  v_mfma_f32_32x32x16_bf16 v[80:95], v[188:191], v[212:215], v[80:95]
  ds_read_b64_tr_b16 v[172:173], v219 offset:40960
  s_add_u32 m0, s45, 77824
  ds_read_b64_tr_b16 v[174:175], v219 offset:41472
  buffer_load_dwordx4 v225, s[16:19], s42 offen lds
  v_mfma_f32_32x32x16_bf16 v[96:111], v[192:195], v[208:211], v[96:111]
  ds_read_b64_tr_b16 v[176:177], v220 offset:40960
  s_add_u32 m0, s45, 81920
  ds_read_b64_tr_b16 v[178:179], v220 offset:41472
  buffer_load_dwordx4 v226, s[20:23], s42 offen lds
  v_mfma_f32_32x32x16_bf16 v[112:127], v[192:195], v[212:215], v[112:127]
  s_add_u32 m0, s45, 86016
  s_nop 0
  buffer_load_dwordx4 v229, s[24:27], s41 offen lds
  ds_read_b64_tr_b16 a[28:29], v255 offset:6144
  ds_read_b64_tr_b16 a[30:31], v255 offset:7168
  v_mfma_f32_32x32x16_bf16 v[128:143], v[196:199], v[208:211], v[128:143]
  s_add_u32 m0, s52, 4096
  s_nop 0
  buffer_load_dwordx4 v239, s[48:51], s75 offen lds
  v_mfma_f32_32x32x16_bf16 v[144:159], v[196:199], v[212:215], v[144:159]
  s_add_u32 m0, s52, 5120
  s_nop 0
  buffer_load_dwordx4 v227, s[48:51], s75 offen lds
  s_waitcnt lgkmcnt(0)
  v_mfma_f32_32x32x16_bf16 v[0:15], v[160:163], v[200:203], v[0:15]
  ds_read_b128 v[208:211], v224 offset:32768
  ds_read_b128 v[212:215], v224 offset:36864
  s_add_u32 s75, s75, 16384
  s_cmp_eq_u32 s75, 458752
  s_cselect_b32 s75, 0, s75
  v_mfma_f32_32x32x16_bf16 v[16:31], v[160:163], v[204:207], v[16:31]
  ds_read_b64_tr_b16 v[180:181], v216 offset:43008
  ds_read_b64_tr_b16 v[182:183], v216 offset:43520
  s_waitcnt vmcnt(27)
  ds_read_b64_tr_b16 a[32:33], v254 offset:8192
  ds_read_b64_tr_b16 a[34:35], v254 offset:9216
  v_mfma_f32_32x32x16_bf16 v[32:47], v[164:167], v[200:203], v[32:47]
  ds_read_b64_tr_b16 v[184:185], v217 offset:43008
  ds_read_b64_tr_b16 v[186:187], v217 offset:43520
  ds_read_b64_tr_b16 a[36:37], v255 offset:8192
  ds_read_b64_tr_b16 a[38:39], v255 offset:9216
  v_mfma_f32_32x32x16_bf16 v[48:63], v[164:167], v[204:207], v[48:63]
  ds_read_b64_tr_b16 v[188:189], v218 offset:43008
  s_add_u32 m0, s52, 6144
  ds_read_b64_tr_b16 v[190:191], v218 offset:43520
  buffer_load_dwordx4 v239, s[48:51], s75 offen lds
  v_mfma_f32_32x32x16_bf16 v[64:79], v[168:171], v[200:203], v[64:79]
  ds_read_b64_tr_b16 v[192:193], v219 offset:43008
  s_add_u32 m0, s52, 7168
  ds_read_b64_tr_b16 v[194:195], v219 offset:43520
  buffer_load_dwordx4 v227, s[48:51], s75 offen lds
  v_mfma_f32_32x32x16_bf16 v[80:95], v[168:171], v[204:207], v[80:95]
  ds_read_b64_tr_b16 v[196:197], v220 offset:43008
  ds_read_b64_tr_b16 v[198:199], v220 offset:43520
  s_add_u32 s75, s75, 16384
  s_cmp_eq_u32 s75, 458752
  s_cselect_b32 s75, 0, s75
  v_mfma_f32_32x32x16_bf16 v[96:111], v[172:175], v[200:203], v[96:111]
  v_mfma_f32_32x32x16_bf16 v[112:127], v[172:175], v[204:207], v[112:127]
  v_mfma_f32_32x32x16_bf16 v[128:143], v[176:179], v[200:203], v[128:143]
  v_mfma_f32_32x32x16_bf16 v[144:159], v[176:179], v[204:207], v[144:159]
  s_waitcnt lgkmcnt(0)
  v_mfma_f32_32x32x16_bf16 v[0:15], v[180:183], v[208:211], v[0:15]
  s_waitcnt vmcnt(17)
  s_barrier
  s_cmp_eq_u32 s34, 0
  s_cbranch_scc0 K12A_sig_cs
  s_lshl_b32 s58, s67, 7
  s_add_u32 s58, s58, 102400
  v_mov_b32 v249, s58
  v_mov_b32 v248, 1
  s_mov_b64 s[60:61], exec
  s_mov_b64 exec, 1
  global_atomic_add v249, v248, s[32:33] sc1
  s_mov_b64 exec, s[60:61]
K12A_sig_cs:
  v_mfma_f32_32x32x16_bf16 v[16:31], v[180:183], v[212:215], v[16:31]
  ds_read_b128 v[200:203], v221 offset:0
  ds_read_b128 v[204:207], v221 offset:4096
  s_add_u32 s39, s39, 32
  s_and_b32 s39, s39, 511
  s_waitcnt vmcnt(27)
  v_mfma_f32_32x32x16_bf16 v[32:47], v[184:187], v[208:211], v[32:47]
  ds_read_b64_tr_b16 v[160:161], v216 offset:0
  ds_read_b64_tr_b16 v[162:163], v216 offset:512
  s_mul_i32 s41, s39, 3072
  s_mul_i32 s42, s39, 3584
  v_mfma_f32_32x32x16_bf16 v[48:63], v[184:187], v[212:215], v[48:63]
  ds_read_b64_tr_b16 v[164:165], v217 offset:0
  s_add_u32 m0, s45, 90112
  ds_read_b64_tr_b16 v[166:167], v217 offset:512
  buffer_load_dwordx4 v225, s[8:11], s42 offen lds
  v_mfma_f32_32x32x16_bf16 v[64:79], v[188:191], v[208:211], v[64:79]
  ds_read_b64_tr_b16 v[168:169], v218 offset:0
  s_add_u32 m0, s45, 94208
  ds_read_b64_tr_b16 v[170:171], v218 offset:512
  buffer_load_dwordx4 v226, s[12:15], s42 offen lds
  v_mfma_f32_32x32x16_bf16 v[80:95], v[188:191], v[212:215], v[80:95]
  ds_read_b64_tr_b16 v[172:173], v219 offset:0
  s_add_u32 m0, s45, 98304
  ds_read_b64_tr_b16 v[174:175], v219 offset:512
  buffer_load_dwordx4 v225, s[16:19], s42 offen lds
  v_mfma_f32_32x32x16_bf16 v[96:111], v[192:195], v[208:211], v[96:111]
  ds_read_b64_tr_b16 v[176:177], v220 offset:0
  s_add_u32 m0, s45, 102400
  ds_read_b64_tr_b16 v[178:179], v220 offset:512
  buffer_load_dwordx4 v226, s[20:23], s42 offen lds
  v_mfma_f32_32x32x16_bf16 v[112:127], v[192:195], v[212:215], v[112:127]
  s_add_u32 m0, s45, 106496
  s_nop 0
  buffer_load_dwordx4 v229, s[24:27], s41 offen lds
  ds_read_b64_tr_b16 a[40:41], v254 offset:10240
  ds_read_b64_tr_b16 a[42:43], v254 offset:11264
  v_mfma_f32_32x32x16_bf16 v[128:143], v[196:199], v[208:211], v[128:143]
  s_add_u32 s44, s44, 128
  s_and_b32 s44, s44, 1023
  s_add_u32 s59, s47, s44
  s_add_u32 m0, s46, 32768
  s_nop 0
  buffer_load_dwordx4 v230, s[4:7], s59 offen lds
  v_mfma_f32_32x32x16_bf16 v[144:159], v[196:199], v[212:215], v[144:159]
  s_add_u32 m0, s46, 33792
  s_nop 0
  buffer_load_dwordx4 v231, s[4:7], s59 offen lds
  ds_read_b64_tr_b16 a[44:45], v255 offset:10240
  ds_read_b64_tr_b16 a[46:47], v255 offset:11264
  s_waitcnt lgkmcnt(0)
  v_mfma_f32_32x32x16_bf16 v[0:15], v[160:163], v[200:203], v[0:15]
  ds_read_b128 v[208:211], v222 offset:0
  s_add_u32 m0, s46, 34816
  ds_read_b128 v[212:215], v222 offset:4096
  buffer_load_dwordx4 v232, s[4:7], s59 offen lds
  v_mfma_f32_32x32x16_bf16 v[16:31], v[160:163], v[204:207], v[16:31]
  ds_read_b64_tr_b16 v[180:181], v216 offset:2048
  s_add_u32 m0, s46, 35840
  ds_read_b64_tr_b16 v[182:183], v216 offset:2560
  buffer_load_dwordx4 v233, s[4:7], s59 offen lds
  v_mfma_f32_32x32x16_bf16 v[32:47], v[164:167], v[200:203], v[32:47]
  ds_read_b64_tr_b16 v[184:185], v217 offset:2048
  s_add_u32 m0, s52, 8192
  ds_read_b64_tr_b16 v[186:187], v217 offset:2560
  buffer_load_dwordx4 v239, s[48:51], s75 offen lds
  v_mfma_f32_32x32x16_bf16 v[48:63], v[164:167], v[204:207], v[48:63]
  ds_read_b64_tr_b16 v[188:189], v218 offset:2048
  s_add_u32 m0, s52, 9216
  ds_read_b64_tr_b16 v[190:191], v218 offset:2560
  buffer_load_dwordx4 v227, s[48:51], s75 offen lds
  v_mfma_f32_32x32x16_bf16 v[64:79], v[168:171], v[200:203], v[64:79]
  ds_read_b64_tr_b16 v[192:193], v219 offset:2048
  ds_read_b64_tr_b16 v[194:195], v219 offset:2560
  s_add_u32 s75, s75, 16384
  s_cmp_eq_u32 s75, 458752
  s_cselect_b32 s75, 0, s75
  v_mfma_f32_32x32x16_bf16 v[80:95], v[168:171], v[204:207], v[80:95]
  ds_read_b64_tr_b16 v[196:197], v220 offset:2048
  ds_read_b64_tr_b16 v[198:199], v220 offset:2560
  s_waitcnt vmcnt(22)
  ds_read_b64_tr_b16 a[48:49], v254 offset:0
  ds_read_b64_tr_b16 a[50:51], v254 offset:1024
  v_mfma_f32_32x32x16_bf16 v[96:111], v[172:175], v[200:203], v[96:111]
  ds_read_b64_tr_b16 a[52:53], v255 offset:0
  s_add_u32 m0, s52, 10240
  ds_read_b64_tr_b16 a[54:55], v255 offset:1024
  buffer_load_dwordx4 v239, s[48:51], s75 offen lds
  v_mfma_f32_32x32x16_bf16 v[112:127], v[172:175], v[204:207], v[112:127]
  s_add_u32 m0, s52, 11264
  s_nop 0
  buffer_load_dwordx4 v227, s[48:51], s75 offen lds
  v_mfma_f32_32x32x16_bf16 v[128:143], v[176:179], v[200:203], v[128:143]
  s_add_u32 s75, s75, 16384
  s_cmp_eq_u32 s75, 458752
  s_cselect_b32 s75, 0, s75
  v_mfma_f32_32x32x16_bf16 v[144:159], v[176:179], v[204:207], v[144:159]
  s_waitcnt lgkmcnt(0)
  v_mfma_f32_32x32x16_bf16 v[0:15], v[180:183], v[208:211], v[0:15]
  s_waitcnt vmcnt(17)
  s_barrier
  s_waitcnt vmcnt(22)
  ds_read_b64_tr_b16 a[56:57], v254 offset:2048
  ds_read_b64_tr_b16 a[58:59], v254 offset:3072
  v_mfma_f32_32x32x16_bf16 v[16:31], v[180:183], v[212:215], v[16:31]
  ds_read_b128 v[200:203], v223 offset:0
  ds_read_b128 v[204:207], v223 offset:4096
  s_add_u32 s39, s39, 32
  s_and_b32 s39, s39, 511
  v_mfma_f32_32x32x16_bf16 v[32:47], v[184:187], v[208:211], v[32:47]
  ds_read_b64_tr_b16 v[160:161], v216 offset:20480
  ds_read_b64_tr_b16 v[162:163], v216 offset:20992
  s_mul_i32 s41, s39, 3072
  s_mul_i32 s42, s39, 3584
  v_mfma_f32_32x32x16_bf16 v[48:63], v[184:187], v[212:215], v[48:63]
  ds_read_b64_tr_b16 v[164:165], v217 offset:20480
  s_add_u32 m0, s45, 49152
  ds_read_b64_tr_b16 v[166:167], v217 offset:20992
  buffer_load_dwordx4 v225, s[8:11], s42 offen lds
  v_mfma_f32_32x32x16_bf16 v[64:79], v[188:191], v[208:211], v[64:79]
  ds_read_b64_tr_b16 v[168:169], v218 offset:20480
  s_add_u32 m0, s45, 53248
  ds_read_b64_tr_b16 v[170:171], v218 offset:20992
  buffer_load_dwordx4 v226, s[12:15], s42 offen lds
  v_mfma_f32_32x32x16_bf16 v[80:95], v[188:191], v[212:215], v[80:95]
  ds_read_b64_tr_b16 v[172:173], v219 offset:20480
  s_add_u32 m0, s45, 57344
  ds_read_b64_tr_b16 v[174:175], v219 offset:20992
  buffer_load_dwordx4 v225, s[16:19], s42 offen lds
  v_mfma_f32_32x32x16_bf16 v[96:111], v[192:195], v[208:211], v[96:111]
  ds_read_b64_tr_b16 v[176:177], v220 offset:20480
  s_add_u32 m0, s45, 61440
  ds_read_b64_tr_b16 v[178:179], v220 offset:20992
  buffer_load_dwordx4 v226, s[20:23], s42 offen lds
  v_mfma_f32_32x32x16_bf16 v[112:127], v[192:195], v[212:215], v[112:127]
  s_add_u32 m0, s45, 65536
  s_nop 0
  buffer_load_dwordx4 v229, s[24:27], s41 offen lds
  ds_read_b64_tr_b16 a[60:61], v255 offset:2048
  ds_read_b64_tr_b16 a[62:63], v255 offset:3072
  v_mfma_f32_32x32x16_bf16 v[128:143], v[196:199], v[208:211], v[128:143]
  s_add_u32 m0, s52, 0
  s_nop 0
  buffer_load_dwordx4 v239, s[48:51], s75 offen lds
  v_mfma_f32_32x32x16_bf16 v[144:159], v[196:199], v[212:215], v[144:159]
  s_add_u32 m0, s52, 1024
  s_nop 0
  buffer_load_dwordx4 v227, s[48:51], s75 offen lds
  s_waitcnt lgkmcnt(0)
  v_mfma_f32_32x32x16_bf16 v[0:15], v[160:163], v[200:203], v[0:15]
  ds_read_b128 v[208:211], v224 offset:0
  ds_read_b128 v[212:215], v224 offset:4096
  s_add_u32 s75, s75, 16384
  s_cmp_eq_u32 s75, 458752
  s_cselect_b32 s75, 0, s75
  v_mfma_f32_32x32x16_bf16 v[16:31], v[160:163], v[204:207], v[16:31]
  ds_read_b64_tr_b16 v[180:181], v216 offset:22528
  ds_read_b64_tr_b16 v[182:183], v216 offset:23040
  s_waitcnt vmcnt(22)
  ds_read_b64_tr_b16 a[64:65], v254 offset:4096
  ds_read_b64_tr_b16 a[66:67], v254 offset:5120
  v_mfma_f32_32x32x16_bf16 v[32:47], v[164:167], v[200:203], v[32:47]
  ds_read_b64_tr_b16 v[184:185], v217 offset:22528
  ds_read_b64_tr_b16 v[186:187], v217 offset:23040
  ds_read_b64_tr_b16 a[68:69], v255 offset:4096
  ds_read_b64_tr_b16 a[70:71], v255 offset:5120
  v_mfma_f32_32x32x16_bf16 v[48:63], v[164:167], v[204:207], v[48:63]
  ds_read_b64_tr_b16 v[188:189], v218 offset:22528
  s_add_u32 m0, s52, 2048
  ds_read_b64_tr_b16 v[190:191], v218 offset:23040
  buffer_load_dwordx4 v239, s[48:51], s75 offen lds
  v_mfma_f32_32x32x16_bf16 v[64:79], v[168:171], v[200:203], v[64:79]
  ds_read_b64_tr_b16 v[192:193], v219 offset:22528
  s_add_u32 m0, s52, 3072
  ds_read_b64_tr_b16 v[194:195], v219 offset:23040
  buffer_load_dwordx4 v227, s[48:51], s75 offen lds
  v_mfma_f32_32x32x16_bf16 v[80:95], v[168:171], v[204:207], v[80:95]
  ds_read_b64_tr_b16 v[196:197], v220 offset:22528
  ds_read_b64_tr_b16 v[198:199], v220 offset:23040
  s_add_u32 s75, s75, 16384
  s_cmp_eq_u32 s75, 458752
  s_cselect_b32 s75, 0, s75
  v_mfma_f32_32x32x16_bf16 v[96:111], v[172:175], v[200:203], v[96:111]
  v_mfma_f32_32x32x16_bf16 v[112:127], v[172:175], v[204:207], v[112:127]
  v_mfma_f32_32x32x16_bf16 v[128:143], v[176:179], v[200:203], v[128:143]
  v_mfma_f32_32x32x16_bf16 v[144:159], v[176:179], v[204:207], v[144:159]
  s_waitcnt lgkmcnt(0)
  v_mfma_f32_32x32x16_bf16 v[0:15], v[180:183], v[208:211], v[0:15]
  s_waitcnt vmcnt(17)
  s_barrier
  s_waitcnt vmcnt(22)
  ds_read_b64_tr_b16 a[72:73], v254 offset:6144
  ds_read_b64_tr_b16 a[74:75], v254 offset:7168
  v_mfma_f32_32x32x16_bf16 v[16:31], v[180:183], v[212:215], v[16:31]
  ds_read_b128 v[200:203], v221 offset:16384
  ds_read_b128 v[204:207], v221 offset:20480
  s_add_u32 s39, s39, 32
  s_and_b32 s39, s39, 511
  v_mfma_f32_32x32x16_bf16 v[32:47], v[184:187], v[208:211], v[32:47]
  ds_read_b64_tr_b16 v[160:161], v216 offset:40960
  ds_read_b64_tr_b16 v[162:163], v216 offset:41472
  s_mul_i32 s41, s39, 3072
  s_mul_i32 s42, s39, 3584
  v_mfma_f32_32x32x16_bf16 v[48:63], v[184:187], v[212:215], v[48:63]
  ds_read_b64_tr_b16 v[164:165], v217 offset:40960
  s_add_u32 m0, s45, 69632
  ds_read_b64_tr_b16 v[166:167], v217 offset:41472
  buffer_load_dwordx4 v225, s[8:11], s42 offen lds
  v_mfma_f32_32x32x16_bf16 v[64:79], v[188:191], v[208:211], v[64:79]
  ds_read_b64_tr_b16 v[168:169], v218 offset:40960
  s_add_u32 m0, s45, 73728
  ds_read_b64_tr_b16 v[170:171], v218 offset:41472
  buffer_load_dwordx4 v226, s[12:15], s42 offen lds
  v_mfma_f32_32x32x16_bf16 v[80:95], v[188:191], v[212:215], v[80:95]
  ds_read_b64_tr_b16 v[172:173], v219 offset:40960
  s_add_u32 m0, s45, 77824
  ds_read_b64_tr_b16 v[174:175], v219 offset:41472
  buffer_load_dwordx4 v225, s[16:19], s42 offen lds
  v_mfma_f32_32x32x16_bf16 v[96:111], v[192:195], v[208:211], v[96:111]
  ds_read_b64_tr_b16 v[176:177], v220 offset:40960
  s_add_u32 m0, s45, 81920
  ds_read_b64_tr_b16 v[178:179], v220 offset:41472
  buffer_load_dwordx4 v226, s[20:23], s42 offen lds
  v_mfma_f32_32x32x16_bf16 v[112:127], v[192:195], v[212:215], v[112:127]
  s_add_u32 m0, s45, 86016
  s_nop 0
  buffer_load_dwordx4 v229, s[24:27], s41 offen lds
  ds_read_b64_tr_b16 a[76:77], v255 offset:6144
  ds_read_b64_tr_b16 a[78:79], v255 offset:7168
  v_mfma_f32_32x32x16_bf16 v[128:143], v[196:199], v[208:211], v[128:143]
  s_add_u32 s44, s44, 128
  s_and_b32 s44, s44, 1023
  s_add_u32 s59, s47, s44
  s_add_u32 m0, s46, 0
  s_nop 0
  buffer_load_dwordx4 v230, s[4:7], s59 offen lds
  v_mfma_f32_32x32x16_bf16 v[144:159], v[196:199], v[212:215], v[144:159]
  s_add_u32 m0, s46, 1024
  s_nop 0
  buffer_load_dwordx4 v231, s[4:7], s59 offen lds
  s_add_u32 m0, s52, 4096
  s_nop 0
  buffer_load_dwordx4 v239, s[48:51], s75 offen lds
  s_waitcnt lgkmcnt(0)
  v_mfma_f32_32x32x16_bf16 v[0:15], v[160:163], v[200:203], v[0:15]
  ds_read_b128 v[208:211], v222 offset:16384
  s_add_u32 m0, s46, 2048
  ds_read_b128 v[212:215], v222 offset:20480
  buffer_load_dwordx4 v232, s[4:7], s59 offen lds
  v_mfma_f32_32x32x16_bf16 v[16:31], v[160:163], v[204:207], v[16:31]
  ds_read_b64_tr_b16 v[180:181], v216 offset:43008
  s_add_u32 m0, s46, 3072
  ds_read_b64_tr_b16 v[182:183], v216 offset:43520
  buffer_load_dwordx4 v233, s[4:7], s59 offen lds
  v_mfma_f32_32x32x16_bf16 v[32:47], v[164:167], v[200:203], v[32:47]
  ds_read_b64_tr_b16 v[184:185], v217 offset:43008
  s_add_u32 m0, s52, 5120
  ds_read_b64_tr_b16 v[186:187], v217 offset:43520
  buffer_load_dwordx4 v227, s[48:51], s75 offen lds
  v_mfma_f32_32x32x16_bf16 v[48:63], v[164:167], v[204:207], v[48:63]
  ds_read_b64_tr_b16 v[188:189], v218 offset:43008
  ds_read_b64_tr_b16 v[190:191], v218 offset:43520
  s_add_u32 s75, s75, 16384
  s_cmp_eq_u32 s75, 458752
  s_cselect_b32 s75, 0, s75
  v_mfma_f32_32x32x16_bf16 v[64:79], v[168:171], v[200:203], v[64:79]
  ds_read_b64_tr_b16 v[192:193], v219 offset:43008
  ds_read_b64_tr_b16 v[194:195], v219 offset:43520
  s_waitcnt vmcnt(22)
  ds_read_b64_tr_b16 a[80:81], v254 offset:8192
  ds_read_b64_tr_b16 a[82:83], v254 offset:9216
  v_mfma_f32_32x32x16_bf16 v[80:95], v[168:171], v[204:207], v[80:95]
  ds_read_b64_tr_b16 v[196:197], v220 offset:43008
  ds_read_b64_tr_b16 v[198:199], v220 offset:43520
  ds_read_b64_tr_b16 a[84:85], v255 offset:8192
  ds_read_b64_tr_b16 a[86:87], v255 offset:9216
  v_mfma_f32_32x32x16_bf16 v[96:111], v[172:175], v[200:203], v[96:111]
  s_add_u32 m0, s52, 6144
  s_nop 0
  buffer_load_dwordx4 v239, s[48:51], s75 offen lds
  v_mfma_f32_32x32x16_bf16 v[112:127], v[172:175], v[204:207], v[112:127]
  s_add_u32 m0, s52, 7168
  s_nop 0
  buffer_load_dwordx4 v227, s[48:51], s75 offen lds
  v_mfma_f32_32x32x16_bf16 v[128:143], v[176:179], v[200:203], v[128:143]
  s_add_u32 s75, s75, 16384
  s_cmp_eq_u32 s75, 458752
  s_cselect_b32 s75, 0, s75
  v_mfma_f32_32x32x16_bf16 v[144:159], v[176:179], v[204:207], v[144:159]
  s_waitcnt lgkmcnt(0)
  v_mfma_f32_32x32x16_bf16 v[0:15], v[180:183], v[208:211], v[0:15]
  s_waitcnt vmcnt(17)
  s_barrier
  s_waitcnt vmcnt(22)
  ds_read_b64_tr_b16 a[88:89], v254 offset:10240
  ds_read_b64_tr_b16 a[90:91], v254 offset:11264
  v_mfma_f32_32x32x16_bf16 v[16:31], v[180:183], v[212:215], v[16:31]
  ds_read_b128 v[200:203], v223 offset:16384
  ds_read_b128 v[204:207], v223 offset:20480
  s_add_u32 s39, s39, 32
  s_and_b32 s39, s39, 511
  v_mfma_f32_32x32x16_bf16 v[32:47], v[184:187], v[208:211], v[32:47]
  ds_read_b64_tr_b16 v[160:161], v216 offset:0
  ds_read_b64_tr_b16 v[162:163], v216 offset:512
  s_mul_i32 s41, s39, 3072
  s_mul_i32 s42, s39, 3584
  v_mfma_f32_32x32x16_bf16 v[48:63], v[184:187], v[212:215], v[48:63]
  ds_read_b64_tr_b16 v[164:165], v217 offset:0
  s_add_u32 m0, s45, 90112
  ds_read_b64_tr_b16 v[166:167], v217 offset:512
  buffer_load_dwordx4 v225, s[8:11], s42 offen lds
  v_mfma_f32_32x32x16_bf16 v[64:79], v[188:191], v[208:211], v[64:79]
  ds_read_b64_tr_b16 v[168:169], v218 offset:0
  s_add_u32 m0, s45, 94208
  ds_read_b64_tr_b16 v[170:171], v218 offset:512
  buffer_load_dwordx4 v226, s[12:15], s42 offen lds
  v_mfma_f32_32x32x16_bf16 v[80:95], v[188:191], v[212:215], v[80:95]
  ds_read_b64_tr_b16 v[172:173], v219 offset:0
  s_add_u32 m0, s45, 98304
  ds_read_b64_tr_b16 v[174:175], v219 offset:512
  buffer_load_dwordx4 v225, s[16:19], s42 offen lds
  v_mfma_f32_32x32x16_bf16 v[96:111], v[192:195], v[208:211], v[96:111]
  ds_read_b64_tr_b16 v[176:177], v220 offset:0
  s_add_u32 m0, s45, 102400
  ds_read_b64_tr_b16 v[178:179], v220 offset:512
  buffer_load_dwordx4 v226, s[20:23], s42 offen lds
  v_mfma_f32_32x32x16_bf16 v[112:127], v[192:195], v[212:215], v[112:127]
  s_add_u32 m0, s45, 106496
  s_nop 0
  buffer_load_dwordx4 v229, s[24:27], s41 offen lds
  ds_read_b64_tr_b16 a[92:93], v255 offset:10240
  ds_read_b64_tr_b16 a[94:95], v255 offset:11264
  v_mfma_f32_32x32x16_bf16 v[128:143], v[196:199], v[208:211], v[128:143]
  s_add_u32 m0, s52, 8192
  s_nop 0
  buffer_load_dwordx4 v239, s[48:51], s75 offen lds
  v_mfma_f32_32x32x16_bf16 v[144:159], v[196:199], v[212:215], v[144:159]
  s_add_u32 m0, s52, 9216
  s_nop 0
  buffer_load_dwordx4 v227, s[48:51], s75 offen lds
  s_waitcnt lgkmcnt(0)
  v_mfma_f32_32x32x16_bf16 v[0:15], v[160:163], v[200:203], v[0:15]
  ds_read_b128 v[208:211], v224 offset:16384
  ds_read_b128 v[212:215], v224 offset:20480
  s_add_u32 s75, s75, 16384
  s_cmp_eq_u32 s75, 458752
  s_cselect_b32 s75, 0, s75
  v_mfma_f32_32x32x16_bf16 v[16:31], v[160:163], v[204:207], v[16:31]
  ds_read_b64_tr_b16 v[180:181], v216 offset:2048
  ds_read_b64_tr_b16 v[182:183], v216 offset:2560
  s_waitcnt vmcnt(22)
  ds_read_b64_tr_b16 a[96:97], v254 offset:0
  ds_read_b64_tr_b16 a[98:99], v254 offset:1024
  v_mfma_f32_32x32x16_bf16 v[32:47], v[164:167], v[200:203], v[32:47]
  ds_read_b64_tr_b16 v[184:185], v217 offset:2048
  ds_read_b64_tr_b16 v[186:187], v217 offset:2560
  ds_read_b64_tr_b16 a[100:101], v255 offset:0
  ds_read_b64_tr_b16 a[102:103], v255 offset:1024
  v_mfma_f32_32x32x16_bf16 v[48:63], v[164:167], v[204:207], v[48:63]
  ds_read_b64_tr_b16 v[188:189], v218 offset:2048
  s_add_u32 m0, s52, 10240
  ds_read_b64_tr_b16 v[190:191], v218 offset:2560
  buffer_load_dwordx4 v239, s[48:51], s75 offen lds
  v_mfma_f32_32x32x16_bf16 v[64:79], v[168:171], v[200:203], v[64:79]
  ds_read_b64_tr_b16 v[192:193], v219 offset:2048
  s_add_u32 m0, s52, 11264
  ds_read_b64_tr_b16 v[194:195], v219 offset:2560
  buffer_load_dwordx4 v227, s[48:51], s75 offen lds
  v_mfma_f32_32x32x16_bf16 v[80:95], v[168:171], v[204:207], v[80:95]
  ds_read_b64_tr_b16 v[196:197], v220 offset:2048
  ds_read_b64_tr_b16 v[198:199], v220 offset:2560
  s_add_u32 s75, s75, 16384
  s_cmp_eq_u32 s75, 458752
  s_cselect_b32 s75, 0, s75
  v_mfma_f32_32x32x16_bf16 v[96:111], v[172:175], v[200:203], v[96:111]
  v_mfma_f32_32x32x16_bf16 v[112:127], v[172:175], v[204:207], v[112:127]
  v_mfma_f32_32x32x16_bf16 v[128:143], v[176:179], v[200:203], v[128:143]
  v_mfma_f32_32x32x16_bf16 v[144:159], v[176:179], v[204:207], v[144:159]
  s_cmp_eq_u32 s34, 0
  s_cbranch_scc0 K12A_w0_cntld
  s_lshl_b32 s58, s37, 7
  s_add_u32 s58, s58, 100352
  v_mov_b32 v247, s58
  s_lshl_b32 s58, s67, 7
  s_add_u32 s58, s58, 102400
  v_mov_b32 v248, s58
  s_mov_b64 s[60:61], exec
  s_mov_b64 exec, 1
  global_load_dword v245, v247, s[32:33] sc1
  global_load_dword v246, v248, s[32:33] sc1
  s_mov_b64 exec, s[60:61]
K12A_w0_cntld:
  s_waitcnt lgkmcnt(0)
  v_mfma_f32_32x32x16_bf16 v[0:15], v[180:183], v[208:211], v[0:15]
  s_waitcnt vmcnt(17)
  s_barrier
  s_waitcnt vmcnt(22)
  ds_read_b64_tr_b16 a[104:105], v254 offset:2048
  ds_read_b64_tr_b16 a[106:107], v254 offset:3072
  v_mfma_f32_32x32x16_bf16 v[16:31], v[180:183], v[212:215], v[16:31]
  ds_read_b128 v[200:203], v221 offset:32768
  ds_read_b128 v[204:207], v221 offset:36864
  s_add_u32 s39, s39, 32
  s_and_b32 s39, s39, 511
  v_mfma_f32_32x32x16_bf16 v[32:47], v[184:187], v[208:211], v[32:47]
  ds_read_b64_tr_b16 v[160:161], v216 offset:20480
  ds_read_b64_tr_b16 v[162:163], v216 offset:20992
  s_mul_i32 s41, s39, 3072
  s_mul_i32 s42, s39, 3584
  v_mfma_f32_32x32x16_bf16 v[48:63], v[184:187], v[212:215], v[48:63]
  ds_read_b64_tr_b16 v[164:165], v217 offset:20480
  s_add_u32 m0, s45, 49152
  ds_read_b64_tr_b16 v[166:167], v217 offset:20992
  buffer_load_dwordx4 v225, s[8:11], s42 offen lds
  v_mfma_f32_32x32x16_bf16 v[64:79], v[188:191], v[208:211], v[64:79]
  ds_read_b64_tr_b16 v[168:169], v218 offset:20480
  s_add_u32 m0, s45, 53248
  ds_read_b64_tr_b16 v[170:171], v218 offset:20992
  buffer_load_dwordx4 v226, s[12:15], s42 offen lds
  v_mfma_f32_32x32x16_bf16 v[80:95], v[188:191], v[212:215], v[80:95]
  ds_read_b64_tr_b16 v[172:173], v219 offset:20480
  s_add_u32 m0, s45, 57344
  ds_read_b64_tr_b16 v[174:175], v219 offset:20992
  buffer_load_dwordx4 v225, s[16:19], s42 offen lds
  v_mfma_f32_32x32x16_bf16 v[96:111], v[192:195], v[208:211], v[96:111]
  ds_read_b64_tr_b16 v[176:177], v220 offset:20480
  s_add_u32 m0, s45, 61440
  ds_read_b64_tr_b16 v[178:179], v220 offset:20992
  buffer_load_dwordx4 v226, s[20:23], s42 offen lds
  v_mfma_f32_32x32x16_bf16 v[112:127], v[192:195], v[212:215], v[112:127]
  s_add_u32 m0, s45, 65536
  s_nop 0
  buffer_load_dwordx4 v229, s[24:27], s41 offen lds
  ds_read_b64_tr_b16 a[108:109], v255 offset:2048
  ds_read_b64_tr_b16 a[110:111], v255 offset:3072
  v_mfma_f32_32x32x16_bf16 v[128:143], v[196:199], v[208:211], v[128:143]
  s_add_u32 s44, s44, 128
  s_and_b32 s44, s44, 1023
  s_add_u32 s59, s47, s44
  s_add_u32 m0, s46, 16384
  s_nop 0
  buffer_load_dwordx4 v230, s[4:7], s59 offen lds
  v_mfma_f32_32x32x16_bf16 v[144:159], v[196:199], v[212:215], v[144:159]
  s_add_u32 m0, s46, 17408
  s_nop 0
  buffer_load_dwordx4 v231, s[4:7], s59 offen lds
  s_add_u32 m0, s52, 0
  s_nop 0
  buffer_load_dwordx4 v239, s[48:51], s75 offen lds
  s_waitcnt lgkmcnt(0)
  v_mfma_f32_32x32x16_bf16 v[0:15], v[160:163], v[200:203], v[0:15]
  ds_read_b128 v[208:211], v222 offset:32768
  s_add_u32 m0, s46, 18432
  ds_read_b128 v[212:215], v222 offset:36864
  buffer_load_dwordx4 v232, s[4:7], s59 offen lds
  v_mfma_f32_32x32x16_bf16 v[16:31], v[160:163], v[204:207], v[16:31]
  ds_read_b64_tr_b16 v[180:181], v216 offset:22528
  s_add_u32 m0, s46, 19456
  ds_read_b64_tr_b16 v[182:183], v216 offset:23040
  buffer_load_dwordx4 v233, s[4:7], s59 offen lds
  v_mfma_f32_32x32x16_bf16 v[32:47], v[164:167], v[200:203], v[32:47]
  ds_read_b64_tr_b16 v[184:185], v217 offset:22528
  s_add_u32 m0, s52, 1024
  ds_read_b64_tr_b16 v[186:187], v217 offset:23040
  buffer_load_dwordx4 v227, s[48:51], s75 offen lds
  v_mfma_f32_32x32x16_bf16 v[48:63], v[164:167], v[204:207], v[48:63]
  ds_read_b64_tr_b16 v[188:189], v218 offset:22528
  ds_read_b64_tr_b16 v[190:191], v218 offset:23040
  s_add_u32 s75, s75, 16384
  s_cmp_eq_u32 s75, 458752
  s_cselect_b32 s75, 0, s75
  v_mfma_f32_32x32x16_bf16 v[64:79], v[168:171], v[200:203], v[64:79]
  ds_read_b64_tr_b16 v[192:193], v219 offset:22528
  ds_read_b64_tr_b16 v[194:195], v219 offset:23040
  s_waitcnt vmcnt(22)
  ds_read_b64_tr_b16 a[112:113], v254 offset:4096
  ds_read_b64_tr_b16 a[114:115], v254 offset:5120
  v_mfma_f32_32x32x16_bf16 v[80:95], v[168:171], v[204:207], v[80:95]
  ds_read_b64_tr_b16 v[196:197], v220 offset:22528
  ds_read_b64_tr_b16 v[198:199], v220 offset:23040
  ds_read_b64_tr_b16 a[116:117], v255 offset:4096
  ds_read_b64_tr_b16 a[118:119], v255 offset:5120
  v_mfma_f32_32x32x16_bf16 v[96:111], v[172:175], v[200:203], v[96:111]
  s_add_u32 m0, s52, 2048
  s_nop 0
  buffer_load_dwordx4 v239, s[48:51], s75 offen lds
  v_mfma_f32_32x32x16_bf16 v[112:127], v[172:175], v[204:207], v[112:127]
  s_add_u32 m0, s52, 3072
  s_nop 0
  buffer_load_dwordx4 v227, s[48:51], s75 offen lds
  v_mfma_f32_32x32x16_bf16 v[128:143], v[176:179], v[200:203], v[128:143]
  s_add_u32 s75, s75, 16384
  s_cmp_eq_u32 s75, 458752
  s_cselect_b32 s75, 0, s75
  v_mfma_f32_32x32x16_bf16 v[144:159], v[176:179], v[204:207], v[144:159]
  s_waitcnt lgkmcnt(0)
  v_mfma_f32_32x32x16_bf16 v[0:15], v[180:183], v[208:211], v[0:15]
  s_cmp_eq_u32 s34, 0
  s_cbranch_scc0 K12A_w0_cntchk
  s_waitcnt vmcnt(13)
  v_readfirstlane_b32 s58, v245
  s_nop 0
  s_cmp_ge_u32 s58, 16
  s_cbranch_scc1 K12A_stok
  s_mov_b32 s57, 0
K12A_spin_st:
  global_load_dword v250, v247, s[32:33] sc1
  s_waitcnt vmcnt(0)
  v_readfirstlane_b32 s58, v250
  s_add_u32 s57, s57, 1
  s_cmp_ge_u32 s57, 200000
  s_cbranch_scc1 K12A_spin_st_x
  s_cmp_ge_u32 s58, 16
  s_cbranch_scc1 K12A_spin_st_x
  s_sleep 2
  s_branch K12A_spin_st
K12A_spin_st_x:
K12A_stok:
  v_readfirstlane_b32 s58, v246
  s_nop 0
  s_cmp_ge_u32 s58, 16
  s_cbranch_scc1 K12A_csok
  s_mov_b32 s57, 0
K12A_spin_cs:
  global_load_dword v250, v248, s[32:33] sc1
  s_waitcnt vmcnt(0)
  v_readfirstlane_b32 s58, v250
  s_add_u32 s57, s57, 1
  s_cmp_ge_u32 s57, 200000
  s_cbranch_scc1 K12A_spin_cs_x
  s_cmp_ge_u32 s58, 16
  s_cbranch_scc1 K12A_spin_cs_x
  s_sleep 2
  s_branch K12A_spin_cs
K12A_spin_cs_x:
K12A_csok:
K12A_w0_cntchk:
  s_waitcnt vmcnt(17)
  s_barrier
  v_mfma_f32_32x32x16_bf16 v[16:31], v[180:183], v[212:215], v[16:31]
  ds_read_b128 v[200:203], v223 offset:32768
  ds_read_b128 v[204:207], v223 offset:36864
  s_add_u32 s39, s39, 32
  s_and_b32 s39, s39, 511
  s_waitcnt vmcnt(22)
  v_mfma_f32_32x32x16_bf16 v[32:47], v[184:187], v[208:211], v[32:47]
  ds_read_b64_tr_b16 v[160:161], v216 offset:40960
  ds_read_b64_tr_b16 v[162:163], v216 offset:41472
  s_mul_i32 s41, s39, 3072
  s_mul_i32 s42, s39, 3584
  v_mfma_f32_32x32x16_bf16 v[48:63], v[184:187], v[212:215], v[48:63]
  ds_read_b64_tr_b16 v[164:165], v217 offset:40960
  s_add_u32 m0, s45, 69632
  ds_read_b64_tr_b16 v[166:167], v217 offset:41472
  buffer_load_dwordx4 v225, s[8:11], s42 offen lds
  v_mfma_f32_32x32x16_bf16 v[64:79], v[188:191], v[208:211], v[64:79]
  ds_read_b64_tr_b16 v[168:169], v218 offset:40960
  s_add_u32 m0, s45, 73728
  ds_read_b64_tr_b16 v[170:171], v218 offset:41472
  buffer_load_dwordx4 v226, s[12:15], s42 offen lds
  v_mfma_f32_32x32x16_bf16 v[80:95], v[188:191], v[212:215], v[80:95]
  ds_read_b64_tr_b16 v[172:173], v219 offset:40960
  s_add_u32 m0, s45, 77824
  ds_read_b64_tr_b16 v[174:175], v219 offset:41472
  buffer_load_dwordx4 v225, s[16:19], s42 offen lds
  v_mfma_f32_32x32x16_bf16 v[96:111], v[192:195], v[208:211], v[96:111]
  ds_read_b64_tr_b16 v[176:177], v220 offset:40960
  s_add_u32 m0, s45, 81920
  ds_read_b64_tr_b16 v[178:179], v220 offset:41472
  buffer_load_dwordx4 v226, s[20:23], s42 offen lds
  v_mfma_f32_32x32x16_bf16 v[112:127], v[192:195], v[212:215], v[112:127]
  s_add_u32 m0, s45, 86016
  s_nop 0
  buffer_load_dwordx4 v229, s[24:27], s41 offen lds
  ds_read_b64_tr_b16 a[120:121], v254 offset:6144
  ds_read_b64_tr_b16 a[122:123], v254 offset:7168
  v_mfma_f32_32x32x16_bf16 v[128:143], v[196:199], v[208:211], v[128:143]
  v_and_b32 v248, 31, v236
  s_lshl_b32 s58, s37, 7
  s_lshl_b32 s57, s35, 6
  s_add_u32 s58, s58, s57
  v_mfma_f32_32x32x16_bf16 v[144:159], v[196:199], v[212:215], v[144:159]
  v_add_u32 v248, s58, v248
  v_lshlrev_b32 v248, 2, v248
  v_add_u32 v249, 8192, v248
  global_load_dword v240, v248, s[32:33] sc1
  global_load_dword v241, v248, s[32:33] offset:128 sc1
  s_waitcnt lgkmcnt(0)
  v_mfma_f32_32x32x16_bf16 v[0:15], v[160:163], v[200:203], v[0:15]
  ds_read_b128 v[208:211], v224 offset:32768
  ds_read_b128 v[212:215], v224 offset:36864
  global_load_dword v234, v249, s[32:33] sc1
  global_load_dword v235, v249, s[32:33] offset:128 sc1
  global_load_dword v242, v251, s[32:33] offset:0 sc1
  v_mfma_f32_32x32x16_bf16 v[16:31], v[160:163], v[204:207], v[16:31]
  ds_read_b64_tr_b16 v[180:181], v216 offset:43008
  ds_read_b64_tr_b16 v[182:183], v216 offset:43520
  global_load_dword v243, v251, s[32:33] offset:64 sc1
  global_load_dword v244, v251, s[32:33] offset:128 sc1
  global_load_dword v245, v251, s[32:33] offset:192 sc1
  v_mfma_f32_32x32x16_bf16 v[32:47], v[164:167], v[200:203], v[32:47]
  ds_read_b64_tr_b16 v[184:185], v217 offset:43008
  ds_read_b64_tr_b16 v[186:187], v217 offset:43520
  global_load_dword v246, v252, s[32:33] offset:0 sc1
  ds_read_b64_tr_b16 a[124:125], v255 offset:6144
  ds_read_b64_tr_b16 a[126:127], v255 offset:7168
  v_mfma_f32_32x32x16_bf16 v[48:63], v[164:167], v[204:207], v[48:63]
  ds_read_b64_tr_b16 v[188:189], v218 offset:43008
  s_add_u32 m0, s52, 4096
  ds_read_b64_tr_b16 v[190:191], v218 offset:43520
  buffer_load_dwordx4 v239, s[48:51], s75 offen lds
  v_mfma_f32_32x32x16_bf16 v[64:79], v[168:171], v[200:203], v[64:79]
  ds_read_b64_tr_b16 v[192:193], v219 offset:43008
  s_add_u32 m0, s52, 5120
  ds_read_b64_tr_b16 v[194:195], v219 offset:43520
  buffer_load_dwordx4 v227, s[48:51], s75 offen lds
  v_mfma_f32_32x32x16_bf16 v[80:95], v[168:171], v[204:207], v[80:95]
  ds_read_b64_tr_b16 v[196:197], v220 offset:43008
  ds_read_b64_tr_b16 v[198:199], v220 offset:43520
  s_add_u32 s75, s75, 16384
  s_cmp_eq_u32 s75, 458752
  s_cselect_b32 s75, 0, s75
  v_mfma_f32_32x32x16_bf16 v[96:111], v[172:175], v[200:203], v[96:111]
  s_waitcnt vmcnt(31)
  ds_read_b64_tr_b16 a[128:129], v254 offset:8192
  ds_read_b64_tr_b16 a[130:131], v254 offset:9216
  ds_read_b64_tr_b16 a[132:133], v255 offset:8192
  ds_read_b64_tr_b16 a[134:135], v255 offset:9216
  v_mfma_f32_32x32x16_bf16 v[112:127], v[172:175], v[204:207], v[112:127]
  v_mfma_f32_32x32x16_bf16 v[128:143], v[176:179], v[200:203], v[128:143]
  v_mfma_f32_32x32x16_bf16 v[144:159], v[176:179], v[204:207], v[144:159]
  s_waitcnt lgkmcnt(0)
  v_mfma_f32_32x32x16_bf16 v[0:15], v[180:183], v[208:211], v[0:15]
  s_waitcnt vmcnt(24)
  s_barrier
  s_add_u32 m0, s52, 6144
  s_nop 0
  buffer_load_dwordx4 v239, s[48:51], s75 offen lds
  v_mfma_f32_32x32x16_bf16 v[16:31], v[180:183], v[212:215], v[16:31]
  ds_read_b128 v[200:203], v221 offset:0
  ds_read_b128 v[204:207], v221 offset:4096
  s_add_u32 s39, s39, 32
  s_and_b32 s39, s39, 511
  v_mfma_f32_32x32x16_bf16 v[32:47], v[184:187], v[208:211], v[32:47]
  ds_read_b64_tr_b16 v[160:161], v216 offset:0
  ds_read_b64_tr_b16 v[162:163], v216 offset:512
  s_mul_i32 s41, s39, 3072
  s_mul_i32 s42, s39, 3584
  v_mfma_f32_32x32x16_bf16 v[48:63], v[184:187], v[212:215], v[48:63]
  ds_read_b64_tr_b16 v[164:165], v217 offset:0
  s_add_u32 m0, s45, 90112
  ds_read_b64_tr_b16 v[166:167], v217 offset:512
  buffer_load_dwordx4 v225, s[8:11], s42 offen lds
  v_mfma_f32_32x32x16_bf16 v[64:79], v[188:191], v[208:211], v[64:79]
  ds_read_b64_tr_b16 v[168:169], v218 offset:0
  s_add_u32 m0, s45, 94208
  ds_read_b64_tr_b16 v[170:171], v218 offset:512
  buffer_load_dwordx4 v226, s[12:15], s42 offen lds
  v_mfma_f32_32x32x16_bf16 v[80:95], v[188:191], v[212:215], v[80:95]
  ds_read_b64_tr_b16 v[172:173], v219 offset:0
  s_add_u32 m0, s45, 98304
  ds_read_b64_tr_b16 v[174:175], v219 offset:512
  buffer_load_dwordx4 v225, s[16:19], s42 offen lds
  v_mfma_f32_32x32x16_bf16 v[96:111], v[192:195], v[208:211], v[96:111]
  ds_read_b64_tr_b16 v[176:177], v220 offset:0
  s_add_u32 m0, s45, 102400
  ds_read_b64_tr_b16 v[178:179], v220 offset:512
  buffer_load_dwordx4 v226, s[20:23], s42 offen lds
  v_mfma_f32_32x32x16_bf16 v[112:127], v[192:195], v[212:215], v[112:127]
  s_add_u32 m0, s45, 106496
  s_nop 0
  buffer_load_dwordx4 v229, s[24:27], s41 offen lds
  s_add_u32 m0, s52, 7168
  s_nop 0
  buffer_load_dwordx4 v227, s[48:51], s75 offen lds
  v_mfma_f32_32x32x16_bf16 v[128:143], v[196:199], v[208:211], v[128:143]
  s_add_u32 s75, s75, 16384
  s_cmp_eq_u32 s75, 458752
  s_cselect_b32 s75, 0, s75
  s_waitcnt vmcnt(36)
  v_mfma_f32_32x32x16_bf16 v[144:159], v[196:199], v[212:215], v[144:159]
  ds_read_b64_tr_b16 a[136:137], v254 offset:10240
  ds_read_b64_tr_b16 a[138:139], v254 offset:11264
  ds_read_b64_tr_b16 a[140:141], v255 offset:10240
  ds_read_b64_tr_b16 a[142:143], v255 offset:11264
  s_waitcnt lgkmcnt(0)
  v_mfma_f32_32x32x16_bf16 v[0:15], v[160:163], v[200:203], v[0:15]
  ds_read_b128 v[208:211], v222 offset:0
  s_add_u32 m0, s52, 8192
  ds_read_b128 v[212:215], v222 offset:4096
  buffer_load_dwordx4 v239, s[48:51], s75 offen lds
  v_mfma_f32_32x32x16_bf16 v[16:31], v[160:163], v[204:207], v[16:31]
  ds_read_b64_tr_b16 v[180:181], v216 offset:2048
  s_add_u32 m0, s52, 9216
  ds_read_b64_tr_b16 v[182:183], v216 offset:2560
  buffer_load_dwordx4 v227, s[48:51], s75 offen lds
  v_mfma_f32_32x32x16_bf16 v[32:47], v[164:167], v[200:203], v[32:47]
  ds_read_b64_tr_b16 v[184:185], v217 offset:2048
  ds_read_b64_tr_b16 v[186:187], v217 offset:2560
  s_add_u32 s75, s75, 16384
  s_cmp_eq_u32 s75, 458752
  s_cselect_b32 s75, 0, s75
  v_mfma_f32_32x32x16_bf16 v[48:63], v[164:167], v[204:207], v[48:63]
  ds_read_b64_tr_b16 v[188:189], v218 offset:2048
  ds_read_b64_tr_b16 v[190:191], v218 offset:2560
  s_waitcnt vmcnt(27)
  ds_read_b64_tr_b16 a[144:145], v254 offset:0
  ds_read_b64_tr_b16 a[146:147], v254 offset:1024
  v_mfma_f32_32x32x16_bf16 v[64:79], v[168:171], v[200:203], v[64:79]
  ds_read_b64_tr_b16 v[192:193], v219 offset:2048
  ds_read_b64_tr_b16 v[194:195], v219 offset:2560
  ds_read_b64_tr_b16 a[148:149], v255 offset:0
  ds_read_b64_tr_b16 a[150:151], v255 offset:1024
  v_mfma_f32_32x32x16_bf16 v[80:95], v[168:171], v[204:207], v[80:95]
  ds_read_b64_tr_b16 v[196:197], v220 offset:2048
  s_add_u32 m0, s52, 10240
  ds_read_b64_tr_b16 v[198:199], v220 offset:2560
  buffer_load_dwordx4 v239, s[48:51], s75 offen lds
  v_mfma_f32_32x32x16_bf16 v[96:111], v[172:175], v[200:203], v[96:111]
  s_add_u32 m0, s52, 11264
  s_nop 0
  buffer_load_dwordx4 v227, s[48:51], s75 offen lds
  v_mfma_f32_32x32x16_bf16 v[112:127], v[172:175], v[204:207], v[112:127]
  s_add_u32 s75, s75, 16384
  s_cmp_eq_u32 s75, 458752
  s_cselect_b32 s75, 0, s75
  v_mfma_f32_32x32x16_bf16 v[128:143], v[176:179], v[200:203], v[128:143]
  v_mfma_f32_32x32x16_bf16 v[144:159], v[176:179], v[204:207], v[144:159]
  s_waitcnt lgkmcnt(0)
  v_mfma_f32_32x32x16_bf16 v[0:15], v[180:183], v[208:211], v[0:15]
  s_waitcnt vmcnt(22)
  s_barrier
  s_waitcnt vmcnt(13)
  v_cmp_gt_u32 vcc, 32, v236
  s_nop 1
  v_mfma_f32_32x32x16_bf16 v[16:31], v[180:183], v[212:215], v[16:31]
  ds_read_b128 v[200:203], v223 offset:0
  ds_read_b128 v[204:207], v223 offset:4096
  v_cndmask_b32 v248, 0, v240, vcc
  v_cvt_pk_bf16_f32 v250, v248, v248
  v_and_b32 v249, 0xffff0000, v250
  v_mfma_f32_32x32x16_bf16 v[32:47], v[184:187], v[208:211], v[32:47]
  ds_read_b64_tr_b16 v[160:161], v216 offset:20480
  ds_read_b64_tr_b16 v[162:163], v216 offset:20992
  v_sub_f32 v249, v248, v249
  v_cvt_pk_bf16_f32 v251, v249, 0
  v_accvgpr_write_b32 a228, v250
  v_mfma_f32_32x32x16_bf16 v[48:63], v[184:187], v[212:215], v[48:63]
  ds_read_b64_tr_b16 v[164:165], v217 offset:20480
  ds_read_b64_tr_b16 v[166:167], v217 offset:20992
  v_accvgpr_write_b32 a229, v251
  v_accvgpr_write_b32 a230, 0
  v_accvgpr_write_b32 a231, 0
  v_mfma_f32_32x32x16_bf16 v[64:79], v[188:191], v[208:211], v[64:79]
  ds_read_b64_tr_b16 v[168:169], v218 offset:20480
  ds_read_b64_tr_b16 v[170:171], v218 offset:20992
  v_cndmask_b32 v248, 0, v241, vcc
  v_cvt_pk_bf16_f32 v250, v248, v248
  v_and_b32 v249, 0xffff0000, v250
  v_mfma_f32_32x32x16_bf16 v[80:95], v[188:191], v[212:215], v[80:95]
  ds_read_b64_tr_b16 v[172:173], v219 offset:20480
  ds_read_b64_tr_b16 v[174:175], v219 offset:20992
  v_sub_f32 v249, v248, v249
  v_cvt_pk_bf16_f32 v251, v249, 0
  v_accvgpr_write_b32 a232, v250
  v_mfma_f32_32x32x16_bf16 v[96:111], v[192:195], v[208:211], v[96:111]
  ds_read_b64_tr_b16 v[176:177], v220 offset:20480
  ds_read_b64_tr_b16 v[178:179], v220 offset:20992
  v_accvgpr_write_b32 a233, v251
  v_accvgpr_write_b32 a234, 0
  v_accvgpr_write_b32 a235, 0
  v_mfma_f32_32x32x16_bf16 v[112:127], v[192:195], v[212:215], v[112:127]
  v_cndmask_b32 v248, 0, v242, vcc
  v_sub_f32 v248, 0, v248
  v_cvt_pk_bf16_f32 v251, v248, 0
  v_lshlrev_b32 v249, 16, v251
  v_sub_f32 v249, v248, v249
  v_mfma_f32_32x32x16_bf16 v[128:143], v[196:199], v[208:211], v[128:143]
  v_cvt_pk_bf16_f32 v250, v248, v249
  v_accvgpr_write_b32 a236, v250
  v_accvgpr_write_b32 a237, v251
  v_accvgpr_write_b32 a238, 0
  v_accvgpr_write_b32 a239, 0
  v_mfma_f32_32x32x16_bf16 v[144:159], v[196:199], v[212:215], v[144:159]
  v_cndmask_b32 v248, 0, v243, vcc
  v_sub_f32 v248, 0, v248
  v_cvt_pk_bf16_f32 v251, v248, 0
  v_lshlrev_b32 v249, 16, v251
  v_sub_f32 v249, v248, v249
  s_waitcnt lgkmcnt(0)
  v_mfma_f32_32x32x16_bf16 v[0:15], v[160:163], v[200:203], v[0:15]
  ds_read_b128 v[208:211], v224 offset:0
  ds_read_b128 v[212:215], v224 offset:4096
  v_cvt_pk_bf16_f32 v250, v248, v249
  v_accvgpr_write_b32 a240, v250
  v_accvgpr_write_b32 a241, v251
  v_mfma_f32_32x32x16_bf16 v[16:31], v[160:163], v[204:207], v[16:31]
  ds_read_b64_tr_b16 v[180:181], v216 offset:22528
  ds_read_b64_tr_b16 v[182:183], v216 offset:23040
  v_accvgpr_write_b32 a242, 0
  v_accvgpr_write_b32 a243, 0
  v_cndmask_b32 v248, 0, v244, vcc
  v_mfma_f32_32x32x16_bf16 v[32:47], v[164:167], v[200:203], v[32:47]
  ds_read_b64_tr_b16 v[184:185], v217 offset:22528
  ds_read_b64_tr_b16 v[186:187], v217 offset:23040
  v_sub_f32 v248, 0, v248
  v_cvt_pk_bf16_f32 v251, v248, 0
  v_lshlrev_b32 v249, 16, v251
  v_mfma_f32_32x32x16_bf16 v[48:63], v[164:167], v[204:207], v[48:63]
  ds_read_b64_tr_b16 v[188:189], v218 offset:22528
  ds_read_b64_tr_b16 v[190:191], v218 offset:23040
  v_sub_f32 v249, v248, v249
  v_cvt_pk_bf16_f32 v250, v248, v249
  v_accvgpr_write_b32 a244, v250
  v_mfma_f32_32x32x16_bf16 v[64:79], v[168:171], v[200:203], v[64:79]
  ds_read_b64_tr_b16 v[192:193], v219 offset:22528
  ds_read_b64_tr_b16 v[194:195], v219 offset:23040
  v_accvgpr_write_b32 a245, v251
  v_accvgpr_write_b32 a246, 0
  v_accvgpr_write_b32 a247, 0
  v_mfma_f32_32x32x16_bf16 v[80:95], v[168:171], v[204:207], v[80:95]
  ds_read_b64_tr_b16 v[196:197], v220 offset:22528
  ds_read_b64_tr_b16 v[198:199], v220 offset:23040
  v_cndmask_b32 v248, 0, v245, vcc
  v_sub_f32 v248, 0, v248
  v_cvt_pk_bf16_f32 v251, v248, 0
  v_mfma_f32_32x32x16_bf16 v[96:111], v[172:175], v[200:203], v[96:111]
  v_lshlrev_b32 v249, 16, v251
  v_sub_f32 v249, v248, v249
  v_cvt_pk_bf16_f32 v250, v248, v249
  v_accvgpr_write_b32 a248, v250
  v_accvgpr_write_b32 a249, v251
  v_mfma_f32_32x32x16_bf16 v[112:127], v[172:175], v[204:207], v[112:127]
  v_accvgpr_write_b32 a250, 0
  v_accvgpr_write_b32 a251, 0
  v_cndmask_b32 v248, 0, v246, vcc
  v_sub_f32 v248, 0, v248
  v_cvt_pk_bf16_f32 v251, v248, 0
  v_mfma_f32_32x32x16_bf16 v[128:143], v[176:179], v[200:203], v[128:143]
  v_lshlrev_b32 v249, 16, v251
  v_sub_f32 v249, v248, v249
  v_cvt_pk_bf16_f32 v250, v248, v249
  v_accvgpr_write_b32 a252, v250
  v_accvgpr_write_b32 a253, v251
  v_mfma_f32_32x32x16_bf16 v[144:159], v[176:179], v[204:207], v[144:159]
  v_accvgpr_write_b32 a254, 0
  v_accvgpr_write_b32 a255, 0
  s_add_u32 s39, s39, 32
  s_and_b32 s39, s39, 511
  s_waitcnt vmcnt(27)
  s_waitcnt lgkmcnt(0)
  v_mfma_f32_32x32x16_bf16 v[0:15], v[180:183], v[208:211], v[0:15]
  s_waitcnt vmcnt(5)
  s_barrier
  s_mul_i32 s41, s39, 3072
  s_mul_i32 s42, s39, 3584
  v_mfma_f32_32x32x16_bf16 v[16:31], v[180:183], v[212:215], v[16:31]
  ds_read_b128 v[200:203], v221 offset:16384
  s_add_u32 m0, s45, 49152
  ds_read_b128 v[204:207], v221 offset:20480
  buffer_load_dwordx4 v225, s[8:11], s42 offen lds
  v_mfma_f32_32x32x16_bf16 v[32:47], v[184:187], v[208:211], v[32:47]
  ds_read_b64_tr_b16 v[160:161], v216 offset:40960
  s_add_u32 m0, s45, 53248
  ds_read_b64_tr_b16 v[162:163], v216 offset:41472
  buffer_load_dwordx4 v226, s[12:15], s42 offen lds
  v_mfma_f32_32x32x16_bf16 v[48:63], v[184:187], v[212:215], v[48:63]
  ds_read_b64_tr_b16 v[164:165], v217 offset:40960
  s_add_u32 m0, s45, 57344
  ds_read_b64_tr_b16 v[166:167], v217 offset:41472
  buffer_load_dwordx4 v225, s[16:19], s42 offen lds
  v_mfma_f32_32x32x16_bf16 v[64:79], v[188:191], v[208:211], v[64:79]
  ds_read_b64_tr_b16 v[168:169], v218 offset:40960
  s_add_u32 m0, s45, 61440
  ds_read_b64_tr_b16 v[170:171], v218 offset:41472
  buffer_load_dwordx4 v226, s[20:23], s42 offen lds
  v_mfma_f32_32x32x16_bf16 v[80:95], v[188:191], v[212:215], v[80:95]
  ds_read_b64_tr_b16 v[172:173], v219 offset:40960
  s_add_u32 m0, s45, 65536
  ds_read_b64_tr_b16 v[174:175], v219 offset:41472
  buffer_load_dwordx4 v229, s[24:27], s41 offen lds
  v_mfma_f32_32x32x16_bf16 v[96:111], v[192:195], v[208:211], v[96:111]
  ds_read_b64_tr_b16 v[176:177], v220 offset:40960
  ds_read_b64_tr_b16 v[178:179], v220 offset:41472
  ds_read_b64_tr_b16 a[152:153], v254 offset:2048
  ds_read_b64_tr_b16 a[154:155], v254 offset:3072
  v_mfma_f32_32x32x16_bf16 v[112:127], v[192:195], v[212:215], v[112:127]
  ds_read_b64_tr_b16 a[156:157], v255 offset:2048
  s_add_u32 m0, s52, 0
  ds_read_b64_tr_b16 a[158:159], v255 offset:3072
  buffer_load_dwordx4 v239, s[48:51], s75 offen lds
  v_mfma_f32_32x32x16_bf16 v[128:143], v[196:199], v[208:211], v[128:143]
  s_add_u32 m0, s52, 1024
  s_nop 0
  buffer_load_dwordx4 v227, s[48:51], s75 offen lds
  v_mfma_f32_32x32x16_bf16 v[144:159], v[196:199], v[212:215], v[144:159]
  s_add_u32 s75, s75, 16384
  s_cmp_eq_u32 s75, 458752
  s_cselect_b32 s75, 0, s75
  s_waitcnt vmcnt(18)
  s_waitcnt lgkmcnt(0)
  v_mfma_f32_32x32x16_bf16 v[0:15], a[236:239], a[228:231], v[0:15]
  ds_read_b64_tr_b16 a[160:161], v254 offset:4096
  ds_read_b64_tr_b16 a[162:163], v254 offset:5120
  ds_read_b64_tr_b16 a[164:165], v255 offset:4096
  ds_read_b64_tr_b16 a[166:167], v255 offset:5120
  v_mfma_f32_32x32x16_bf16 v[16:31], a[236:239], a[232:235], v[16:31]
  s_add_u32 m0, s52, 2048
  s_nop 0
  buffer_load_dwordx4 v239, s[48:51], s75 offen lds
  v_mfma_f32_32x32x16_bf16 v[32:47], a[240:243], a[228:231], v[32:47]
  s_add_u32 m0, s52, 3072
  s_nop 0
  buffer_load_dwordx4 v227, s[48:51], s75 offen lds
  v_mfma_f32_32x32x16_bf16 v[48:63], a[240:243], a[232:235], v[48:63]
  s_add_u32 s75, s75, 16384
  s_cmp_eq_u32 s75, 458752
  s_cselect_b32 s75, 0, s75
  s_waitcnt vmcnt(13)
  v_mfma_f32_32x32x16_bf16 v[64:79], a[244:247], a[228:231], v[64:79]
  ds_read_b64_tr_b16 a[168:169], v254 offset:6144
  ds_read_b64_tr_b16 a[170:171], v254 offset:7168
  ds_read_b64_tr_b16 a[172:173], v255 offset:6144
  ds_read_b64_tr_b16 a[174:175], v255 offset:7168
  v_mfma_f32_32x32x16_bf16 v[80:95], a[244:247], a[232:235], v[80:95]
  v_mfma_f32_32x32x16_bf16 v[96:111], a[248:251], a[228:231], v[96:111]
  v_mfma_f32_32x32x16_bf16 v[112:127], a[248:251], a[232:235], v[112:127]
  v_mfma_f32_32x32x16_bf16 v[128:143], a[252:255], a[228:231], v[128:143]
  v_mfma_f32_32x32x16_bf16 v[144:159], a[252:255], a[232:235], v[144:159]
  s_waitcnt lgkmcnt(0)
  v_mfma_f32_32x32x16_bf16 v[0:15], v[160:163], v[200:203], v[0:15]
  ds_read_b128 v[208:211], v222 offset:16384
  s_add_u32 m0, s52, 4096
  ds_read_b128 v[212:215], v222 offset:20480
  buffer_load_dwordx4 v239, s[48:51], s75 offen lds
  v_mfma_f32_32x32x16_bf16 v[16:31], v[160:163], v[204:207], v[16:31]
  ds_read_b64_tr_b16 v[180:181], v216 offset:43008
  s_add_u32 m0, s52, 5120
  ds_read_b64_tr_b16 v[182:183], v216 offset:43520
  buffer_load_dwordx4 v227, s[48:51], s75 offen lds
  v_mfma_f32_32x32x16_bf16 v[32:47], v[164:167], v[200:203], v[32:47]
  ds_read_b64_tr_b16 v[184:185], v217 offset:43008
  ds_read_b64_tr_b16 v[186:187], v217 offset:43520
  s_add_u32 s75, s75, 16384
  s_cmp_eq_u32 s75, 458752
  s_cselect_b32 s75, 0, s75
  v_mfma_f32_32x32x16_bf16 v[48:63], v[164:167], v[204:207], v[48:63]
  ds_read_b64_tr_b16 v[188:189], v218 offset:43008
  ds_read_b64_tr_b16 v[190:191], v218 offset:43520
  s_waitcnt vmcnt(13)
  ds_read_b64_tr_b16 a[176:177], v254 offset:8192
  ds_read_b64_tr_b16 a[178:179], v254 offset:9216
  v_mfma_f32_32x32x16_bf16 v[64:79], v[168:171], v[200:203], v[64:79]
  ds_read_b64_tr_b16 v[192:193], v219 offset:43008
  ds_read_b64_tr_b16 v[194:195], v219 offset:43520
  ds_read_b64_tr_b16 a[180:181], v255 offset:8192
  ds_read_b64_tr_b16 a[182:183], v255 offset:9216
  v_mfma_f32_32x32x16_bf16 v[80:95], v[168:171], v[204:207], v[80:95]
  ds_read_b64_tr_b16 v[196:197], v220 offset:43008
  s_add_u32 m0, s52, 6144
  ds_read_b64_tr_b16 v[198:199], v220 offset:43520
  buffer_load_dwordx4 v239, s[48:51], s75 offen lds
  v_mfma_f32_32x32x16_bf16 v[96:111], v[172:175], v[200:203], v[96:111]
  s_add_u32 m0, s52, 7168
  s_nop 0
  buffer_load_dwordx4 v227, s[48:51], s75 offen lds
  v_mfma_f32_32x32x16_bf16 v[112:127], v[172:175], v[204:207], v[112:127]
  v_mfma_f32_32x32x16_bf16 v[128:143], v[176:179], v[200:203], v[128:143]
  v_mfma_f32_32x32x16_bf16 v[144:159], v[176:179], v[204:207], v[144:159]
  s_waitcnt lgkmcnt(0)
  v_mfma_f32_32x32x16_bf16 v[0:15], v[180:183], v[208:211], v[0:15]
  s_waitcnt vmcnt(8)
  s_barrier
  s_waitcnt vmcnt(13)
  ds_read_b64_tr_b16 a[184:185], v254 offset:10240
  ds_read_b64_tr_b16 a[186:187], v254 offset:11264
  v_mfma_f32_32x32x16_bf16 v[16:31], v[180:183], v[212:215], v[16:31]
  ds_read_b128 v[200:203], v223 offset:16384
  ds_read_b128 v[204:207], v223 offset:20480
  ds_read_b64_tr_b16 a[188:189], v255 offset:10240
  ds_read_b64_tr_b16 a[190:191], v255 offset:11264
  v_mfma_f32_32x32x16_bf16 v[32:47], v[184:187], v[208:211], v[32:47]
  ds_read_b64_tr_b16 v[160:161], v216 offset:0
  ds_read_b64_tr_b16 v[162:163], v216 offset:512
  v_mfma_f32_32x32x16_bf16 v[48:63], v[184:187], v[212:215], v[48:63]
  ds_read_b64_tr_b16 v[164:165], v217 offset:0
  ds_read_b64_tr_b16 v[166:167], v217 offset:512
  v_mfma_f32_32x32x16_bf16 v[64:79], v[188:191], v[208:211], v[64:79]
  ds_read_b64_tr_b16 v[168:169], v218 offset:0
  ds_read_b64_tr_b16 v[170:171], v218 offset:512
  v_mfma_f32_32x32x16_bf16 v[80:95], v[188:191], v[212:215], v[80:95]
  ds_read_b64_tr_b16 v[172:173], v219 offset:0
  ds_read_b64_tr_b16 v[174:175], v219 offset:512
  v_mfma_f32_32x32x16_bf16 v[96:111], v[192:195], v[208:211], v[96:111]
  ds_read_b64_tr_b16 v[176:177], v220 offset:0
  ds_read_b64_tr_b16 v[178:179], v220 offset:512
  v_mfma_f32_32x32x16_bf16 v[112:127], v[192:195], v[212:215], v[112:127]
  v_mfma_f32_32x32x16_bf16 v[128:143], v[196:199], v[208:211], v[128:143]
  v_mfma_f32_32x32x16_bf16 v[144:159], v[196:199], v[212:215], v[144:159]
  s_waitcnt lgkmcnt(0)
  v_mfma_f32_32x32x16_bf16 v[0:15], v[160:163], v[200:203], v[0:15]
  ds_read_b128 v[208:211], v224 offset:16384
  ds_read_b128 v[212:215], v224 offset:20480
  s_waitcnt vmcnt(6)
  ds_read_b64_tr_b16 a[192:193], v254 offset:0
  ds_read_b64_tr_b16 a[194:195], v254 offset:1024
  v_mfma_f32_32x32x16_bf16 v[16:31], v[160:163], v[204:207], v[16:31]
  ds_read_b64_tr_b16 v[180:181], v216 offset:2048
  ds_read_b64_tr_b16 v[182:183], v216 offset:2560
  ds_read_b64_tr_b16 a[196:197], v255 offset:0
  ds_read_b64_tr_b16 a[198:199], v255 offset:1024
  v_mfma_f32_32x32x16_bf16 v[32:47], v[164:167], v[200:203], v[32:47]
  ds_read_b64_tr_b16 v[184:185], v217 offset:2048
  ds_read_b64_tr_b16 v[186:187], v217 offset:2560
  v_mfma_f32_32x32x16_bf16 v[48:63], v[164:167], v[204:207], v[48:63]
  ds_read_b64_tr_b16 v[188:189], v218 offset:2048
  ds_read_b64_tr_b16 v[190:191], v218 offset:2560
  v_mfma_f32_32x32x16_bf16 v[64:79], v[168:171], v[200:203], v[64:79]
  ds_read_b64_tr_b16 v[192:193], v219 offset:2048
  ds_read_b64_tr_b16 v[194:195], v219 offset:2560
  v_mfma_f32_32x32x16_bf16 v[80:95], v[168:171], v[204:207], v[80:95]
  ds_read_b64_tr_b16 v[196:197], v220 offset:2048
  ds_read_b64_tr_b16 v[198:199], v220 offset:2560
  v_mfma_f32_32x32x16_bf16 v[96:111], v[172:175], v[200:203], v[96:111]
  v_mfma_f32_32x32x16_bf16 v[112:127], v[172:175], v[204:207], v[112:127]
  v_mfma_f32_32x32x16_bf16 v[128:143], v[176:179], v[200:203], v[128:143]
  v_mfma_f32_32x32x16_bf16 v[144:159], v[176:179], v[204:207], v[144:159]
  s_waitcnt lgkmcnt(0)
  v_mfma_f32_32x32x16_bf16 v[0:15], v[180:183], v[208:211], v[0:15]
  s_barrier
  s_waitcnt vmcnt(4)
  ds_read_b64_tr_b16 a[200:201], v254 offset:2048
  ds_read_b64_tr_b16 a[202:203], v254 offset:3072
  v_mfma_f32_32x32x16_bf16 v[16:31], v[180:183], v[212:215], v[16:31]
  ds_read_b64_tr_b16 a[204:205], v255 offset:2048
  ds_read_b64_tr_b16 a[206:207], v255 offset:3072
  s_waitcnt vmcnt(2)
  ds_read_b64_tr_b16 a[208:209], v254 offset:4096
  ds_read_b64_tr_b16 a[210:211], v254 offset:5120
  v_mfma_f32_32x32x16_bf16 v[32:47], v[184:187], v[208:211], v[32:47]
  ds_read_b64_tr_b16 a[212:213], v255 offset:4096
  ds_read_b64_tr_b16 a[214:215], v255 offset:5120
  s_waitcnt vmcnt(0)
  ds_read_b64_tr_b16 a[216:217], v254 offset:6144
  ds_read_b64_tr_b16 a[218:219], v254 offset:7168
  v_mfma_f32_32x32x16_bf16 v[48:63], v[184:187], v[212:215], v[48:63]
  ds_read_b64_tr_b16 a[220:221], v255 offset:6144
  ds_read_b64_tr_b16 a[222:223], v255 offset:7168
  v_mfma_f32_32x32x16_bf16 v[64:79], v[188:191], v[208:211], v[64:79]
  v_mfma_f32_32x32x16_bf16 v[80:95], v[188:191], v[212:215], v[80:95]
  v_mfma_f32_32x32x16_bf16 v[96:111], v[192:195], v[208:211], v[96:111]
  v_mfma_f32_32x32x16_bf16 v[112:127], v[192:195], v[212:215], v[112:127]
  v_mfma_f32_32x32x16_bf16 v[128:143], v[196:199], v[208:211], v[128:143]
  v_mfma_f32_32x32x16_bf16 v[144:159], v[196:199], v[212:215], v[144:159]
  s_waitcnt lgkmcnt(0)
  s_barrier
  s_mul_i32 s54, s34, 22528
  s_add_u32 s54, s54, 69632
  s_sub_u32 s55, s54, s52
  s_mov_b32 s52, s54
  v_add_u32 v254, s55, v254
  v_xor_b32 v255, 64, v254
  s_lshl_b32 s54, s70, 7
  s_lshl_b32 s55, s34, 17
  s_add_u32 s54, s54, s55
  s_add_u32 s8, s68, s54
  s_addc_u32 s9, s69, 0
  s_and_b32 s9, s9, 0xffff
  s_sub_u32 s10, 524288, s54
  s_mov_b32 s11, 0x20000
  s_lshl_b32 s54, s37, 1
  s_add_u32 s54, s54, s35
  s_lshl_b32 s54, s54, 2
  s_lshr_b32 s55, s38, 1
  s_add_u32 s54, s54, s55
  s_mul_i32 s80, s54, 73728
  s_and_b32 s81, s38, 1
  v_mul_f32 v200, v234, v234
  v_mul_f32 v201, v234, v234
  v_mul_f32 v202, v235, v235
  v_mul_f32 v203, v235, v235
  s_lshl_b32 s56, s81, 1
  s_add_u32 s56, s56, s36
  s_lshl_b32 s56, s56, 13
  s_add_u32 s56, s56, s80
  v_pk_mul_f32 v[0:1], v[0:1], v[8:9]
  v_pk_mul_f32 v[2:3], v[2:3], v[10:11]
  v_pk_mul_f32 v[4:5], v[4:5], v[12:13]
  v_pk_mul_f32 v[6:7], v[6:7], v[14:15]
  v_pk_mul_f32 v[0:1], v[0:1], v[200:201]
  v_pk_mul_f32 v[2:3], v[2:3], v[200:201]
  v_pk_mul_f32 v[4:5], v[4:5], v[200:201]
  v_pk_mul_f32 v[6:7], v[6:7], v[200:201]
  v_cvt_pk_bf16_f32 v160, v0, v1
  v_cvt_pk_bf16_f32 v161, v2, v3
  v_cvt_pk_bf16_f32 v162, v4, v5
  v_cvt_pk_bf16_f32 v163, v6, v7
  buffer_store_dwordx4 v[160:163], v237, s[28:31], s56 offen offset:0 sc1
  v_pk_mul_f32 v[16:17], v[16:17], v[24:25]
  v_pk_mul_f32 v[18:19], v[18:19], v[26:27]
  v_pk_mul_f32 v[20:21], v[20:21], v[28:29]
  v_pk_mul_f32 v[22:23], v[22:23], v[30:31]
  v_pk_mul_f32 v[16:17], v[16:17], v[202:203]
  v_pk_mul_f32 v[18:19], v[18:19], v[202:203]
  v_pk_mul_f32 v[20:21], v[20:21], v[202:203]
  v_pk_mul_f32 v[22:23], v[22:23], v[202:203]
  v_cvt_pk_bf16_f32 v164, v16, v17
  v_cvt_pk_bf16_f32 v165, v18, v19
  v_cvt_pk_bf16_f32 v166, v20, v21
  v_cvt_pk_bf16_f32 v167, v22, v23
  buffer_store_dwordx4 v[164:167], v237, s[28:31], s56 offen offset:1024 sc1
  s_add_u32 s56, s56, 2048
  v_pk_mul_f32 v[32:33], v[32:33], v[40:41]
  v_pk_mul_f32 v[34:35], v[34:35], v[42:43]
  v_pk_mul_f32 v[36:37], v[36:37], v[44:45]
  v_pk_mul_f32 v[38:39], v[38:39], v[46:47]
  v_pk_mul_f32 v[32:33], v[32:33], v[200:201]
  v_pk_mul_f32 v[34:35], v[34:35], v[200:201]
  v_pk_mul_f32 v[36:37], v[36:37], v[200:201]
  v_pk_mul_f32 v[38:39], v[38:39], v[200:201]
  v_cvt_pk_bf16_f32 v168, v32, v33
  v_cvt_pk_bf16_f32 v169, v34, v35
  v_cvt_pk_bf16_f32 v170, v36, v37
  v_cvt_pk_bf16_f32 v171, v38, v39
  buffer_store_dwordx4 v[168:171], v237, s[28:31], s56 offen offset:0 sc1
  v_pk_mul_f32 v[48:49], v[48:49], v[56:57]
  v_pk_mul_f32 v[50:51], v[50:51], v[58:59]
  v_pk_mul_f32 v[52:53], v[52:53], v[60:61]
  v_pk_mul_f32 v[54:55], v[54:55], v[62:63]
  v_pk_mul_f32 v[48:49], v[48:49], v[202:203]
  v_pk_mul_f32 v[50:51], v[50:51], v[202:203]
  v_pk_mul_f32 v[52:53], v[52:53], v[202:203]
  v_pk_mul_f32 v[54:55], v[54:55], v[202:203]
  v_cvt_pk_bf16_f32 v172, v48, v49
  v_cvt_pk_bf16_f32 v173, v50, v51
  v_cvt_pk_bf16_f32 v174, v52, v53
  v_cvt_pk_bf16_f32 v175, v54, v55
  buffer_store_dwordx4 v[172:175], v237, s[28:31], s56 offen offset:1024 sc1
  s_add_u32 s56, s56, 2048
  v_pk_mul_f32 v[64:65], v[64:65], v[72:73]
  v_pk_mul_f32 v[66:67], v[66:67], v[74:75]
  v_pk_mul_f32 v[68:69], v[68:69], v[76:77]
  v_pk_mul_f32 v[70:71], v[70:71], v[78:79]
  v_pk_mul_f32 v[64:65], v[64:65], v[200:201]
  v_pk_mul_f32 v[66:67], v[66:67], v[200:201]
  v_pk_mul_f32 v[68:69], v[68:69], v[200:201]
  v_pk_mul_f32 v[70:71], v[70:71], v[200:201]
  v_cvt_pk_bf16_f32 v160, v64, v65
  v_cvt_pk_bf16_f32 v161, v66, v67
  v_cvt_pk_bf16_f32 v162, v68, v69
  v_cvt_pk_bf16_f32 v163, v70, v71
  buffer_store_dwordx4 v[160:163], v237, s[28:31], s56 offen offset:0 sc1
  v_pk_mul_f32 v[80:81], v[80:81], v[88:89]
  v_pk_mul_f32 v[82:83], v[82:83], v[90:91]
  v_pk_mul_f32 v[84:85], v[84:85], v[92:93]
  v_pk_mul_f32 v[86:87], v[86:87], v[94:95]
  v_pk_mul_f32 v[80:81], v[80:81], v[202:203]
  v_pk_mul_f32 v[82:83], v[82:83], v[202:203]
  v_pk_mul_f32 v[84:85], v[84:85], v[202:203]
  v_pk_mul_f32 v[86:87], v[86:87], v[202:203]
  v_cvt_pk_bf16_f32 v164, v80, v81
  v_cvt_pk_bf16_f32 v165, v82, v83
  v_cvt_pk_bf16_f32 v166, v84, v85
  v_cvt_pk_bf16_f32 v167, v86, v87
  buffer_store_dwordx4 v[164:167], v237, s[28:31], s56 offen offset:1024 sc1
  s_add_u32 s56, s56, 2048
  v_pk_mul_f32 v[96:97], v[96:97], v[104:105]
  v_pk_mul_f32 v[98:99], v[98:99], v[106:107]
  v_pk_mul_f32 v[100:101], v[100:101], v[108:109]
  v_pk_mul_f32 v[102:103], v[102:103], v[110:111]
  v_pk_mul_f32 v[96:97], v[96:97], v[200:201]
  v_pk_mul_f32 v[98:99], v[98:99], v[200:201]
  v_pk_mul_f32 v[100:101], v[100:101], v[200:201]
  v_pk_mul_f32 v[102:103], v[102:103], v[200:201]
  v_cvt_pk_bf16_f32 v168, v96, v97
  v_cvt_pk_bf16_f32 v169, v98, v99
  v_cvt_pk_bf16_f32 v170, v100, v101
  v_cvt_pk_bf16_f32 v171, v102, v103
  buffer_store_dwordx4 v[168:171], v237, s[28:31], s56 offen offset:0 sc1
  v_pk_mul_f32 v[112:113], v[112:113], v[120:121]
  v_pk_mul_f32 v[114:115], v[114:115], v[122:123]
  v_pk_mul_f32 v[116:117], v[116:117], v[124:125]
  v_pk_mul_f32 v[118:119], v[118:119], v[126:127]
  v_pk_mul_f32 v[112:113], v[112:113], v[202:203]
  v_pk_mul_f32 v[114:115], v[114:115], v[202:203]
  v_pk_mul_f32 v[116:117], v[116:117], v[202:203]
  v_pk_mul_f32 v[118:119], v[118:119], v[202:203]
  v_cvt_pk_bf16_f32 v172, v112, v113
  v_cvt_pk_bf16_f32 v173, v114, v115
  v_cvt_pk_bf16_f32 v174, v116, v117
  v_cvt_pk_bf16_f32 v175, v118, v119
  buffer_store_dwordx4 v[172:175], v237, s[28:31], s56 offen offset:1024 sc1
  s_mov_b32 s20, 0x358637bd
  s_mov_b32 s21, 0x358637bd
  s_lshl_b32 s56, s81, 2
  s_lshl_b32 s57, s36, 1
  s_add_u32 s56, s56, s57
  s_add_u32 s56, s56, 28
  s_lshl_b32 s56, s56, 11
  s_add_u32 s58, s56, s80
  s_add_u32 s59, s58, 2048
  s_mov_b32 s22, s58
  s_mov_b32 s23, s59
  v_mov_b32 v204, v234
  v_mov_b32 v205, v234
  v_mul_f32 v206, 0x3fb8aa3b, v234
  v_mul_f32 v207, 0x3fb8aa3b, v234
  v_pk_mul_f32 v[240:241], v[128:129], v[206:207]
  v_pk_mul_f32 v[242:243], v[130:131], v[206:207]
  v_pk_fma_f32 v[128:129], v[128:129], v[204:205], s[20:21]
  v_pk_fma_f32 v[130:131], v[130:131], v[204:205], s[20:21]
  v_exp_f32_e64 v240, v240 clamp
  v_exp_f32_e64 v241, v241 clamp
  v_exp_f32_e64 v242, v242 clamp
  v_exp_f32_e64 v243, v243 clamp
  v_max_f32 v128, s20, v128
  v_max_f32 v129, s20, v129
  v_max_f32 v130, s20, v130
  v_max_f32 v131, s20, v131
  v_pk_add_f32 v[128:129], v[128:129], v[240:241]
  v_pk_add_f32 v[130:131], v[130:131], v[242:243]
  v_pk_mul_f32 v[240:241], v[132:133], v[206:207]
  v_pk_mul_f32 v[242:243], v[134:135], v[206:207]
  v_pk_fma_f32 v[132:133], v[132:133], v[204:205], s[20:21]
  v_pk_fma_f32 v[134:135], v[134:135], v[204:205], s[20:21]
  v_exp_f32_e64 v240, v240 clamp
  v_exp_f32_e64 v241, v241 clamp
  v_exp_f32_e64 v242, v242 clamp
  v_exp_f32_e64 v243, v243 clamp
  v_max_f32 v132, s20, v132
  v_max_f32 v133, s20, v133
  v_max_f32 v134, s20, v134
  v_max_f32 v135, s20, v135
  v_pk_add_f32 v[132:133], v[132:133], v[240:241]
  v_pk_add_f32 v[134:135], v[134:135], v[242:243]
  v_pk_mul_f32 v[240:241], v[136:137], v[206:207]
  v_pk_mul_f32 v[242:243], v[138:139], v[206:207]
  v_pk_fma_f32 v[136:137], v[136:137], v[204:205], s[20:21]
  v_pk_fma_f32 v[138:139], v[138:139], v[204:205], s[20:21]
  v_exp_f32_e64 v240, v240 clamp
  v_exp_f32_e64 v241, v241 clamp
  v_exp_f32_e64 v242, v242 clamp
  v_exp_f32_e64 v243, v243 clamp
  v_max_f32 v136, s20, v136
  v_max_f32 v137, s20, v137
  v_max_f32 v138, s20, v138
  v_max_f32 v139, s20, v139
  v_pk_add_f32 v[136:137], v[136:137], v[240:241]
  v_pk_add_f32 v[138:139], v[138:139], v[242:243]
  v_pk_mul_f32 v[240:241], v[140:141], v[206:207]
  v_pk_mul_f32 v[242:243], v[142:143], v[206:207]
  v_pk_fma_f32 v[140:141], v[140:141], v[204:205], s[20:21]
  v_pk_fma_f32 v[142:143], v[142:143], v[204:205], s[20:21]
  v_exp_f32_e64 v240, v240 clamp
  v_exp_f32_e64 v241, v241 clamp
  v_exp_f32_e64 v242, v242 clamp
  v_exp_f32_e64 v243, v243 clamp
  v_max_f32 v140, s20, v140
  v_max_f32 v141, s20, v141
  v_max_f32 v142, s20, v142
  v_max_f32 v143, s20, v143
  v_pk_add_f32 v[140:141], v[140:141], v[240:241]
  v_pk_add_f32 v[142:143], v[142:143], v[242:243]
  v_mov_b32 v245, 1
  s_lshl_b32 s54, s37, 1
  s_add_u32 s54, s54, s35
  s_lshl_b32 s54, s54, 2
  s_lshr_b32 s55, s38, 1
  s_add_u32 s54, s54, s55
  s_lshl_b32 s54, s54, 4
  s_lshl_b32 s55, s81, 1
  s_add_u32 s54, s54, s55
  s_add_u32 s54, s54, s36
  s_add_u32 s54, s54, 0
  s_lshl_b32 s54, s54, 2
  s_add_u32 s54, s54, 69632
  v_mov_b32 v244, s54
  s_mov_b64 s[60:61], exec
  s_mov_b64 exec, 1
  s_waitcnt vmcnt(0)
  global_store_dword v244, v245, s[32:33] sc1
  s_mov_b64 exec, s[60:61]
  s_mov_b32 s53, 0
  s_add_u32 m0, s52, 0
  s_nop 0
  buffer_load_dwordx4 v239, s[8:11], s53 offen lds
  s_add_u32 m0, s52, 1024
  s_nop 0
  buffer_load_dwordx4 v227, s[8:11], s53 offen lds
  s_mov_b32 s53, 16384
  s_add_u32 m0, s52, 2048
  s_nop 0
  buffer_load_dwordx4 v239, s[8:11], s53 offen lds
  s_add_u32 m0, s52, 3072
  s_nop 0
  buffer_load_dwordx4 v227, s[8:11], s53 offen lds
  s_mov_b32 s53, 32768
  s_add_u32 m0, s52, 4096
  s_nop 0
  buffer_load_dwordx4 v239, s[8:11], s53 offen lds
  s_add_u32 m0, s52, 5120
  s_nop 0
  buffer_load_dwordx4 v227, s[8:11], s53 offen lds
  s_mov_b32 s53, 49152
  s_add_u32 m0, s52, 6144
  s_nop 0
  buffer_load_dwordx4 v239, s[8:11], s53 offen lds
  s_add_u32 m0, s52, 7168
  s_nop 0
  buffer_load_dwordx4 v227, s[8:11], s53 offen lds
  s_mov_b32 s53, 65536
  s_add_u32 m0, s52, 8192
  s_nop 0
  buffer_load_dwordx4 v239, s[8:11], s53 offen lds
  s_add_u32 m0, s52, 9216
  s_nop 0
  buffer_load_dwordx4 v227, s[8:11], s53 offen lds
  s_mov_b32 s53, 81920
  s_add_u32 m0, s52, 10240
  s_nop 0
  buffer_load_dwordx4 v239, s[8:11], s53 offen lds
  s_add_u32 m0, s52, 11264
  s_nop 0
  buffer_load_dwordx4 v227, s[8:11], s53 offen lds
  s_mov_b32 s53, 98304
  s_add_u32 m0, s52, 12288
  s_nop 0
  buffer_load_dwordx4 v239, s[8:11], s53 offen lds
  s_add_u32 m0, s52, 13312
  s_nop 0
  buffer_load_dwordx4 v227, s[8:11], s53 offen lds
  s_mov_b32 s53, 114688
  s_add_u32 m0, s52, 14336
  s_nop 0
  buffer_load_dwordx4 v239, s[8:11], s53 offen lds
  s_add_u32 m0, s52, 15360
  s_nop 0
  buffer_load_dwordx4 v227, s[8:11], s53 offen lds
  v_cvt_pk_bf16_f32 v160, v128, v129
  v_cvt_pk_bf16_f32 v161, v130, v131
  v_cvt_pk_bf16_f32 v162, v132, v133
  v_cvt_pk_bf16_f32 v163, v134, v135
  buffer_store_dwordx4 v[160:163], v237, s[28:31], s58 offen offset:0 sc1
  v_cvt_pk_bf16_f32 v164, v136, v137
  v_cvt_pk_bf16_f32 v165, v138, v139
  v_cvt_pk_bf16_f32 v166, v140, v141
  v_cvt_pk_bf16_f32 v167, v142, v143
  buffer_store_dwordx4 v[164:167], v237, s[28:31], s59 offen offset:0 sc1
  v_mov_b32 v204, v235
  v_mov_b32 v205, v235
  v_mul_f32 v206, 0x3fb8aa3b, v235
  v_mul_f32 v207, 0x3fb8aa3b, v235
  v_pk_mul_f32 v[240:241], v[144:145], v[206:207]
  v_pk_mul_f32 v[242:243], v[146:147], v[206:207]
  v_pk_fma_f32 v[144:145], v[144:145], v[204:205], s[20:21]
  v_pk_fma_f32 v[146:147], v[146:147], v[204:205], s[20:21]
  v_exp_f32_e64 v240, v240 clamp
  v_exp_f32_e64 v241, v241 clamp
  v_exp_f32_e64 v242, v242 clamp
  v_exp_f32_e64 v243, v243 clamp
  v_max_f32 v144, s20, v144
  v_max_f32 v145, s20, v145
  v_max_f32 v146, s20, v146
  v_max_f32 v147, s20, v147
  v_pk_add_f32 v[144:145], v[144:145], v[240:241]
  v_pk_add_f32 v[146:147], v[146:147], v[242:243]
  v_pk_mul_f32 v[240:241], v[148:149], v[206:207]
  v_pk_mul_f32 v[242:243], v[150:151], v[206:207]
  v_pk_fma_f32 v[148:149], v[148:149], v[204:205], s[20:21]
  v_pk_fma_f32 v[150:151], v[150:151], v[204:205], s[20:21]
  v_exp_f32_e64 v240, v240 clamp
  v_exp_f32_e64 v241, v241 clamp
  v_exp_f32_e64 v242, v242 clamp
  v_exp_f32_e64 v243, v243 clamp
  v_max_f32 v148, s20, v148
  v_max_f32 v149, s20, v149
  v_max_f32 v150, s20, v150
  v_max_f32 v151, s20, v151
  v_pk_add_f32 v[148:149], v[148:149], v[240:241]
  v_pk_add_f32 v[150:151], v[150:151], v[242:243]
  v_pk_mul_f32 v[240:241], v[152:153], v[206:207]
  v_pk_mul_f32 v[242:243], v[154:155], v[206:207]
  v_pk_fma_f32 v[152:153], v[152:153], v[204:205], s[20:21]
  v_pk_fma_f32 v[154:155], v[154:155], v[204:205], s[20:21]
  v_exp_f32_e64 v240, v240 clamp
  v_exp_f32_e64 v241, v241 clamp
  v_exp_f32_e64 v242, v242 clamp
  v_exp_f32_e64 v243, v243 clamp
  v_max_f32 v152, s20, v152
  v_max_f32 v153, s20, v153
  v_max_f32 v154, s20, v154
  v_max_f32 v155, s20, v155
  v_pk_add_f32 v[152:153], v[152:153], v[240:241]
  v_pk_add_f32 v[154:155], v[154:155], v[242:243]
  v_pk_mul_f32 v[240:241], v[156:157], v[206:207]
  v_pk_mul_f32 v[242:243], v[158:159], v[206:207]
  v_pk_fma_f32 v[156:157], v[156:157], v[204:205], s[20:21]
  v_pk_fma_f32 v[158:159], v[158:159], v[204:205], s[20:21]
  v_exp_f32_e64 v240, v240 clamp
  v_exp_f32_e64 v241, v241 clamp
  v_exp_f32_e64 v242, v242 clamp
  v_exp_f32_e64 v243, v243 clamp
  v_max_f32 v156, s20, v156
  v_max_f32 v157, s20, v157
  v_max_f32 v158, s20, v158
  v_max_f32 v159, s20, v159
  v_pk_add_f32 v[156:157], v[156:157], v[240:241]
  v_pk_add_f32 v[158:159], v[158:159], v[242:243]
  v_cvt_pk_bf16_f32 v168, v144, v145
  v_cvt_pk_bf16_f32 v169, v146, v147
  v_cvt_pk_bf16_f32 v170, v148, v149
  v_cvt_pk_bf16_f32 v171, v150, v151
  buffer_store_dwordx4 v[168:171], v237, s[28:31], s58 offen offset:1024 sc1
  v_cvt_pk_bf16_f32 v172, v152, v153
  v_cvt_pk_bf16_f32 v173, v154, v155
  v_cvt_pk_bf16_f32 v174, v156, v157
  v_cvt_pk_bf16_f32 v175, v158, v159
  buffer_store_dwordx4 v[172:175], v237, s[28:31], s59 offen offset:1024 sc1
  s_branch K12_g2
K12_typeB:
  s_add_u32 s59, s47, s44
  s_add_u32 m0, s46, 0
  s_nop 0
  buffer_load_dwordx4 v230, s[4:7], s59 offen lds
  s_add_u32 m0, s46, 1024
  s_nop 0
  buffer_load_dwordx4 v231, s[4:7], s59 offen lds
  s_add_u32 m0, s46, 2048
  s_nop 0
  buffer_load_dwordx4 v232, s[4:7], s59 offen lds
  s_add_u32 m0, s46, 3072
  s_nop 0
  buffer_load_dwordx4 v233, s[4:7], s59 offen lds
  s_lshl_b32 s54, s38, 7
  s_add_u32 s54, s54, 1024
  s_add_u32 s8, s66, s54
  s_addc_u32 s9, s67, 0
  s_and_b32 s9, s9, 0xffff
  s_sub_u32 s10, 1572864, s54
  s_mov_b32 s11, 0x20000
  s_add_u32 s54, s54, 1024
  s_add_u32 s12, s66, s54
  s_addc_u32 s13, s67, 0
  s_and_b32 s13, s13, 0xffff
  s_sub_u32 s14, 1572864, s54
  s_mov_b32 s15, 0x20000
  s_lshr_b32 s54, s38, 1
  s_mul_i32 s54, s54, 7
  s_and_b32 s55, s38, 1
  s_add_u32 s54, s54, s55
  s_add_u32 s54, s54, 4
  s_lshl_b32 s54, s54, 7
  s_add_u32 s16, s72, s54
  s_addc_u32 s17, s73, 0
  s_and_b32 s17, s17, 0xffff
  s_sub_u32 s18, 1835008, s54
  s_mov_b32 s19, 0x20000
  s_add_u32 s20, s74, s54
  s_addc_u32 s21, s75, 0
  s_and_b32 s21, s21, 0xffff
  s_sub_u32 s22, 1835008, s54
  s_mov_b32 s23, 0x20000
  s_lshr_b32 s54, s38, 1
  s_mul_i32 s54, s54, 7
  s_add_u32 s54, s54, 6
  s_lshl_b32 s54, s54, 7
  s_and_b32 s55, s38, 1
  s_lshl_b32 s55, s55, 6
  s_add_u32 s54, s54, s55
  s_cmp_ge_u32 s34, 2
  s_cselect_b32 s56, s74, s72
  s_cselect_b32 s57, s75, s73
  s_add_u32 s24, s56, s54
  s_addc_u32 s25, s57, 0
  s_and_b32 s25, s25, 0xffff
  s_sub_u32 s26, 1835008, s54
  s_mov_b32 s27, 0x20000
  v_lshrrev_b32 v240, 3, v236
  v_and_b32 v241, 7, v236
  v_lshrrev_b32 v242, 4, v236
  v_and_b32 v242, 1, v242
  v_lshlrev_b32 v243, 2, v242
  v_xor_b32 v243, v241, v243
  v_lshlrev_b32 v243, 4, v243
  v_mul_u32_u24 v244, 3072, v240
  v_add_u32 v225, v243, v244
  v_lshlrev_b32 v243, 1, v242
  v_xor_b32 v243, v241, v243
  v_lshlrev_b32 v243, 4, v243
  v_mul_u32_u24 v244, 3584, v240
  v_add_u32 v227, v243, v244
  v_lshlrev_b32 v243, 1, v242
  v_or_b32 v243, 4, v243
  v_xor_b32 v243, v241, v243
  v_lshlrev_b32 v243, 4, v243
  v_mul_u32_u24 v244, 3584, v240
  v_add_u32 v228, v243, v244
  v_lshrrev_b32 v243, 2, v236
  v_and_b32 v244, 3, v236
  s_lshr_b32 s54, s34, 1
  s_lshl_b32 s54, s54, 1
  v_xor_b32 v244, s54, v244
  v_mul_u32_u24 v243, 3584, v243
  v_lshlrev_b32 v244, 4, v244
  v_add_u32 v229, v243, v244
  s_mul_i32 s41, s39, 3072
  s_mul_i32 s42, s39, 3584
  s_mul_i32 s43, s40, 3584
  s_add_u32 m0, s45, 49152
  s_nop 0
  buffer_load_dwordx4 v225, s[8:11], s41 offen lds
  s_add_u32 m0, s45, 53248
  s_nop 0
  buffer_load_dwordx4 v225, s[12:15], s41 offen lds
  s_add_u32 m0, s45, 57344
  s_nop 0
  buffer_load_dwordx4 v227, s[16:19], s42 offen lds
  s_add_u32 m0, s45, 61440
  s_nop 0
  buffer_load_dwordx4 v228, s[20:23], s42 offen lds
  s_add_u32 m0, s45, 65536
  s_nop 0
  buffer_load_dwordx4 v229, s[24:27], s43 offen lds
  s_add_u32 s39, s39, 32
  s_and_b32 s39, s39, 511
  s_add_u32 s40, s40, 32
  s_and_b32 s40, s40, 511
  s_mul_i32 s41, s39, 3072
  s_mul_i32 s42, s39, 3584
  s_mul_i32 s43, s40, 3584
  s_add_u32 m0, s45, 69632
  s_nop 0
  buffer_load_dwordx4 v225, s[8:11], s41 offen lds
  s_add_u32 m0, s45, 73728
  s_nop 0
  buffer_load_dwordx4 v225, s[12:15], s41 offen lds
  s_add_u32 m0, s45, 77824
  s_nop 0
  buffer_load_dwordx4 v227, s[16:19], s42 offen lds
  s_add_u32 m0, s45, 81920
  s_nop 0
  buffer_load_dwordx4 v228, s[20:23], s42 offen lds
  s_add_u32 m0, s45, 86016
  s_nop 0
  buffer_load_dwordx4 v229, s[24:27], s43 offen lds
  v_lshlrev_b32 v243, 2, v242
  v_xor_b32 v243, v241, v243
  v_lshlrev_b32 v243, 4, v243
  v_lshlrev_b32 v244, 10, v240
  v_add_u32 v239, v243, v244
  v_add_u32 v226, 8192, v239
  s_lshl_b32 s54, s70, 7
  s_mul_i32 s55, s34, 458752
  s_add_u32 s54, s54, s55
  s_add_u32 s48, s76, s54
  s_addc_u32 s49, s77, 0
  s_and_b32 s49, s49, 0xffff
  s_sub_u32 s50, 1835008, s54
  s_mov_b32 s51, 0x20000
  s_mul_i32 s52, s34, 12288
  s_add_u32 s52, s52, 110592
  s_lshr_b32 s54, s2, 3
  s_and_b32 s55, s54, 3
  s_mul_i32 s55, s55, 7
  s_lshr_b32 s54, s54, 2
  s_mul_i32 s54, s54, 3
  s_add_u32 s77, s54, s55
  s_cmp_ge_u32 s77, 28
  s_cselect_b32 s54, 28, 0
  s_sub_u32 s77, s77, s54
  s_lshl_b32 s75, s77, 14
  s_load_dwordx2 s[72:73], s[0:1], 64
  s_mov_b32 s67, s81
  s_lshr_b32 s54, s37, 3
  s_lshl_b32 s54, s54, 1
  s_add_u32 s66, s54, s35
  v_and_b32 v240, 31, v236
  v_and_b32 v241, 15, v240
  v_lshrrev_b32 v242, 4, v240
  s_lshl_b32 s54, s38, 6
  s_lshl_b32 s55, s36, 5
  s_add_u32 s54, s54, s55
  s_add_u32 s54, s54, 512
  v_mov_b32 v243, v240
  v_add_u32 v243, s54, v243
  v_lshlrev_b32 v243, 2, v243
  v_add_u32 v252, 79872, v243
  s_lshr_b32 s54, s38, 1
  s_mul_i32 s54, s54, 7
  s_and_b32 s55, s38, 1
  s_add_u32 s54, s54, s55
  s_add_u32 s54, s54, 4
  s_lshl_b32 s54, s54, 6
  s_lshl_b32 s55, s36, 5
  s_add_u32 s54, s54, s55
  s_add_u32 s54, s54, 1536
  v_mul_u32_u24 v243, 1792, v242
  v_add_u32 v243, v243, v241
  v_add_u32 v243, s54, v243
  v_lshlrev_b32 v243, 2, v243
  v_add_u32 v251, 79872, v243
  s_lshr_b32 s54, s38, 1
  s_mul_i32 s54, s54, 7
  s_add_u32 s54, s54, 6
  s_lshl_b32 s54, s54, 6
  s_and_b32 s55, s38, 1
  s_lshl_b32 s55, s55, 1
  s_add_u32 s55, s55, s36
  s_lshl_b32 s55, s55, 4
  s_add_u32 s54, s54, s55
  s_add_u32 s54, s54, 1536
  v_mul_u32_u24 v243, 1792, v242
  v_add_u32 v243, v243, v241
  v_add_u32 v243, s54, v243
  v_lshlrev_b32 v243, 2, v243
  v_add_u32 v253, 79872, v243
  v_mov_b32 v243, 0x3f803f80
  v_accvgpr_write_b32 a220, v243
  v_accvgpr_write_b32 a221, v243
  v_accvgpr_write_b32 a222, v243
  v_accvgpr_write_b32 a223, v243
  s_add_u32 s28, s32, 131072
  s_addc_u32 s29, s33, 0
  s_and_b32 s29, s29, 0xffff
  s_mov_b32 s30, 9437184
  s_mov_b32 s31, 0x20000
  v_lshrrev_b32 v240, 4, v236
  v_and_b32 v240, 1, v240
  v_lshrrev_b32 v241, 5, v236
  v_and_b32 v242, 15, v236
  v_lshrrev_b32 v242, 2, v242
  v_and_b32 v243, 3, v236
  v_lshlrev_b32 v244, 3, v241
  v_add_u32 v244, v244, v242
  v_lshrrev_b32 v245, 1, v242
  v_and_b32 v245, 1, v245
  s_lshl_b32 s54, s36, 1
  v_add_u32 v246, s54, v240
  v_lshlrev_b32 v246, 1, v246
  v_lshrrev_b32 v247, 1, v243
  v_add_u32 v246, v246, v247
  v_lshlrev_b32 v247, 2, v245
  v_xor_b32 v246, v246, v247
  v_lshlrev_b32 v246, 4, v246
  v_lshlrev_b32 v247, 7, v244
  v_add_u32 v246, v246, v247
  v_add_u32 v246, 49152, v246
  v_and_b32 v247, 1, v243
  v_lshlrev_b32 v247, 3, v247
  v_add_u32 v216, v246, v247
  v_add_u32 v217, 4096, v216
  s_lshl_b32 s54, s36, 1
  v_mov_b32 v246, s54
  v_lshlrev_b32 v246, 1, v246
  v_lshrrev_b32 v247, 1, v243
  v_add_u32 v246, v246, v247
  v_lshlrev_b32 v247, 1, v245
  v_lshlrev_b32 v218, 2, v240
  v_or_b32 v247, v247, v218
  v_xor_b32 v246, v246, v247
  v_lshlrev_b32 v246, 4, v246
  v_lshlrev_b32 v247, 7, v244
  v_add_u32 v246, v246, v247
  s_mov_b32 s54, 57344
  v_lshlrev_b32 v247, 12, v240
  v_add_u32 v246, v246, v247
  v_add_u32 v246, s54, v246
  v_and_b32 v247, 1, v243
  v_lshlrev_b32 v247, 3, v247
  v_add_u32 v218, v246, v247
  v_xor_b32 v219, 32, v218
  v_lshrrev_b32 v246, 1, v243
  s_lshl_b32 s54, s36, 1
  v_add_u32 v246, s54, v246
  v_lshlrev_b32 v247, 1, v240
  v_xor_b32 v246, v246, v247
  v_lshlrev_b32 v246, 4, v246
  v_lshlrev_b32 v247, 6, v244
  v_add_u32 v246, v246, v247
  v_lshlrev_b32 v247, 11, v240
  v_add_u32 v246, v246, v247
  v_add_u32 v246, 65536, v246
  v_and_b32 v247, 1, v243
  v_lshlrev_b32 v247, 3, v247
  v_add_u32 v220, v246, v247
  v_lshlrev_b32 v246, 2, v241
  v_add_u32 v246, v246, v242
  v_lshlrev_b32 v246, 7, v246
  v_lshlrev_b32 v247, 1, v240
  v_lshrrev_b32 v254, 1, v243
  v_add_u32 v247, v247, v254
  v_lshlrev_b32 v254, 2, v245
  v_xor_b32 v247, v247, v254
  v_lshlrev_b32 v247, 4, v247
  v_add_u32 v246, v246, v247
  v_and_b32 v247, 1, v243
  v_lshlrev_b32 v247, 3, v247
  v_add_u32 v246, v246, v247
  v_add_u32 v254, s52, v246
  v_xor_b32 v255, 64, v254
  v_and_b32 v246, 31, v236
  s_lshl_b32 s54, s35, 6
  v_add_u32 v246, s54, v246
  v_lshrrev_b32 v247, 1, v246
  v_and_b32 v247, 7, v247
  v_xor_b32 v247, v247, v241
  v_lshlrev_b32 v247, 4, v247
  v_lshlrev_b32 v246, 7, v246
  v_add_u32 v246, v246, v247
  v_xor_b32 v221, 0, v246
  v_xor_b32 v222, 32, v246
  v_xor_b32 v223, 64, v246
  v_xor_b32 v224, 96, v246
  s_add_u32 s44, s44, 128
  s_and_b32 s44, s44, 1023
  s_add_u32 s59, s47, s44
  s_add_u32 m0, s46, 16384
  s_nop 0
  buffer_load_dwordx4 v230, s[4:7], s59 offen lds
  s_add_u32 m0, s46, 17408
  s_nop 0
  buffer_load_dwordx4 v231, s[4:7], s59 offen lds
  s_add_u32 m0, s46, 18432
  s_nop 0
  buffer_load_dwordx4 v232, s[4:7], s59 offen lds
  s_add_u32 m0, s46, 19456
  s_nop 0
  buffer_load_dwordx4 v233, s[4:7], s59 offen lds
  s_waitcnt vmcnt(18)
  v_lshlrev_b32 v248, 16, v180
  v_and_b32 v249, 0xffff0000, v180
  v_pk_mul_f32 v[244:245], v[248:249], v[248:249]
  v_mov_b32 v240, v248
  v_mov_b32 v241, v249
  v_lshlrev_b32 v248, 16, v181
  v_and_b32 v249, 0xffff0000, v181
  v_pk_add_f32 v[240:241], v[240:241], v[248:249]
  v_pk_fma_f32 v[244:245], v[248:249], v[248:249], v[244:245]
  v_lshlrev_b32 v248, 16, v182
  v_and_b32 v249, 0xffff0000, v182
  v_pk_add_f32 v[240:241], v[240:241], v[248:249]
  v_pk_fma_f32 v[244:245], v[248:249], v[248:249], v[244:245]
  v_lshlrev_b32 v248, 16, v183
  v_and_b32 v249, 0xffff0000, v183
  v_pk_add_f32 v[240:241], v[240:241], v[248:249]
  v_pk_fma_f32 v[244:245], v[248:249], v[248:249], v[244:245]
  v_lshlrev_b32 v248, 16, v184
  v_and_b32 v249, 0xffff0000, v184
  v_pk_mul_f32 v[246:247], v[248:249], v[248:249]
  v_mov_b32 v242, v248
  v_mov_b32 v243, v249
  v_lshlrev_b32 v248, 16, v185
  v_and_b32 v249, 0xffff0000, v185
  v_pk_add_f32 v[242:243], v[242:243], v[248:249]
  v_pk_fma_f32 v[246:247], v[248:249], v[248:249], v[246:247]
  v_lshlrev_b32 v248, 16, v186
  v_and_b32 v249, 0xffff0000, v186
  v_pk_add_f32 v[242:243], v[242:243], v[248:249]
  v_pk_fma_f32 v[246:247], v[248:249], v[248:249], v[246:247]
  v_lshlrev_b32 v248, 16, v187
  v_and_b32 v249, 0xffff0000, v187
  v_pk_add_f32 v[242:243], v[242:243], v[248:249]
  v_pk_fma_f32 v[246:247], v[248:249], v[248:249], v[246:247]
  v_add_f32 v240, v240, v241
  v_add_f32 v242, v242, v243
  v_add_f32 v244, v244, v245
  v_add_f32 v246, v246, v247
  v_add_f32_dpp v240, v240, v240 row_shr:1 row_mask:0xf bank_mask:0xf
  v_add_f32_dpp v242, v242, v242 row_shr:1 row_mask:0xf bank_mask:0xf
  v_add_f32_dpp v244, v244, v244 row_shr:1 row_mask:0xf bank_mask:0xf
  v_add_f32_dpp v246, v246, v246 row_shr:1 row_mask:0xf bank_mask:0xf
  v_add_f32_dpp v240, v240, v240 row_shr:2 row_mask:0xf bank_mask:0xf
  v_add_f32_dpp v242, v242, v242 row_shr:2 row_mask:0xf bank_mask:0xf
  v_add_f32_dpp v244, v244, v244 row_shr:2 row_mask:0xf bank_mask:0xf
  v_add_f32_dpp v246, v246, v246 row_shr:2 row_mask:0xf bank_mask:0xf
  v_add_f32_dpp v240, v240, v240 row_shr:4 row_mask:0xf bank_mask:0xf
  v_add_f32_dpp v242, v242, v242 row_shr:4 row_mask:0xf bank_mask:0xf
  v_add_f32_dpp v244, v244, v244 row_shr:4 row_mask:0xf bank_mask:0xf
  v_add_f32_dpp v246, v246, v246 row_shr:4 row_mask:0xf bank_mask:0xf
  v_add_f32_dpp v240, v240, v240 row_shr:8 row_mask:0xf bank_mask:0xf
  v_add_f32_dpp v242, v242, v242 row_shr:8 row_mask:0xf bank_mask:0xf
  v_add_f32_dpp v244, v244, v244 row_shr:8 row_mask:0xf bank_mask:0xf
  v_add_f32_dpp v246, v246, v246 row_shr:8 row_mask:0xf bank_mask:0xf
  v_add_f32_dpp v240, v240, v240 row_bcast:15 row_mask:0xa bank_mask:0xf
  v_add_f32_dpp v242, v242, v242 row_bcast:15 row_mask:0xa bank_mask:0xf
  v_add_f32_dpp v244, v244, v244 row_bcast:15 row_mask:0xa bank_mask:0xf
  v_add_f32_dpp v246, v246, v246 row_bcast:15 row_mask:0xa bank_mask:0xf
  v_add_f32_dpp v240, v240, v240 row_bcast:31 row_mask:0xc bank_mask:0xf
  v_add_f32_dpp v242, v242, v242 row_bcast:31 row_mask:0xc bank_mask:0xf
  v_add_f32_dpp v244, v244, v244 row_bcast:31 row_mask:0xc bank_mask:0xf
  v_add_f32_dpp v246, v246, v246 row_bcast:31 row_mask:0xc bank_mask:0xf
  v_mul_f32 v240, 0x3b000000, v240
  v_mul_f32 v241, 0x3b000000, v242
  v_mul_f32 v244, 0x3b000000, v244
  v_mul_f32 v245, 0x3b000000, v246
  v_fma_f32 v244, -v240, v240, v244
  v_max_f32 v244, 0, v244
  v_add_f32 v244, 0x3727c5ac, v244
  v_rsq_f32 v244, v244
  v_fma_f32 v245, -v241, v241, v245
  v_max_f32 v245, 0, v245
  v_add_f32 v245, 0x3727c5ac, v245
  v_rsq_f32 v245, v245
  v_mov_b32 v248, s80
  v_add_u32 v249, 8192, v248
  s_mov_b64 s[60:61], exec
  s_mov_b32 exec_lo, 0
  s_mov_b32 exec_hi, 0x80000000
  global_store_dwordx2 v248, v[240:241], s[32:33] sc1
  global_store_dwordx2 v249, v[244:245], s[32:33] sc1
  s_mov_b64 exec, s[60:61]
  s_waitcnt lgkmcnt(0)
  s_waitcnt vmcnt(11)
  s_barrier
  ds_read_b128 v[200:203], v221 offset:0
  ds_read_b128 v[204:207], v221 offset:4096
  ds_read_b64_tr_b16 v[160:161], v216 offset:0
  ds_read_b64_tr_b16 v[162:163], v216 offset:512
  ds_read_b64_tr_b16 v[164:165], v217 offset:0
  ds_read_b64_tr_b16 v[166:167], v217 offset:512
  ds_read_b64_tr_b16 v[168:169], v218 offset:0
  ds_read_b64_tr_b16 v[170:171], v218 offset:512
  ds_read_b64_tr_b16 v[172:173], v219 offset:0
  ds_read_b64_tr_b16 v[174:175], v219 offset:512
  ds_read_b64_tr_b16 v[176:177], v220 offset:0
  ds_read_b64_tr_b16 v[178:179], v220 offset:256
  s_cmp_lt_u32 s2, 18
  s_cbranch_scc0 K12B_sig_init
  s_cmp_eq_u32 s34, 0
  s_cbranch_scc0 K12B_sig_init
  v_mov_b32 v249, 0
  v_mov_b32 v248, 1
  s_mov_b64 s[60:61], exec
  s_mov_b64 exec, 1
  global_atomic_add v249, v248, s[72:73] sc1
  s_mov_b64 exec, s[60:61]
K12B_sig_init:
  s_waitcnt lgkmcnt(0)
  v_mfma_f32_32x32x16_bf16 v[0:15], v[200:203], v[160:163], 0
  ds_read_b128 v[208:211], v222 offset:0
  ds_read_b128 v[212:215], v222 offset:4096
  s_add_u32 s39, s39, 32
  s_and_b32 s39, s39, 511
  v_mfma_f32_32x32x16_bf16 v[16:31], v[204:207], v[160:163], 0
  ds_read_b64_tr_b16 v[180:181], v216 offset:2048
  ds_read_b64_tr_b16 v[182:183], v216 offset:2560
  s_add_u32 s40, s40, 32
  s_and_b32 s40, s40, 511
  v_mfma_f32_32x32x16_bf16 v[32:47], v[200:203], v[164:167], 0
  ds_read_b64_tr_b16 v[184:185], v217 offset:2048
  ds_read_b64_tr_b16 v[186:187], v217 offset:2560
  s_mul_i32 s41, s39, 3072
  s_mul_i32 s42, s39, 3584
  s_mul_i32 s43, s40, 3584
  v_mfma_f32_32x32x16_bf16 v[48:63], v[204:207], v[164:167], 0
  ds_read_b64_tr_b16 v[188:189], v218 offset:2048
  s_add_u32 m0, s45, 90112
  ds_read_b64_tr_b16 v[190:191], v218 offset:2560
  buffer_load_dwordx4 v225, s[8:11], s41 offen lds
  v_mfma_f32_32x32x16_bf16 v[64:79], v[168:171], v[200:203], 0
  ds_read_b64_tr_b16 v[192:193], v219 offset:2048
  s_add_u32 m0, s45, 94208
  ds_read_b64_tr_b16 v[194:195], v219 offset:2560
  buffer_load_dwordx4 v225, s[12:15], s41 offen lds
  v_mfma_f32_32x32x16_bf16 v[80:95], v[168:171], v[204:207], 0
  ds_read_b64_tr_b16 v[196:197], v220 offset:1024
  s_add_u32 m0, s45, 98304
  ds_read_b64_tr_b16 v[198:199], v220 offset:1280
  buffer_load_dwordx4 v227, s[16:19], s42 offen lds
  v_mfma_f32_32x32x16_bf16 v[96:111], v[172:175], v[200:203], 0
  s_add_u32 m0, s45, 102400
  s_nop 0
  buffer_load_dwordx4 v228, s[20:23], s42 offen lds
  v_mfma_f32_32x32x16_bf16 v[112:127], v[172:175], v[204:207], 0
  s_add_u32 m0, s45, 106496
  s_nop 0
  buffer_load_dwordx4 v229, s[24:27], s43 offen lds
  v_mfma_f32_32x32x16_bf16 v[128:143], v[176:179], v[200:203], 0
  v_mfma_f32_32x32x16_bf16 v[144:159], v[176:179], v[204:207], 0
  s_cmp_eq_u32 s66, 0
  s_cbranch_scc0 K12B_nocs0
  v_mfma_f32_32x32x16_bf16 a[140:155], a[220:223], v[160:163], 0
  v_mfma_f32_32x32x16_bf16 a[156:171], a[220:223], v[164:167], 0
  v_mfma_f32_32x32x16_bf16 a[172:187], a[220:223], v[168:171], 0
  v_mfma_f32_32x32x16_bf16 a[188:203], a[220:223], v[172:175], 0
  v_mfma_f32_32x32x16_bf16 a[204:219], a[220:223], v[176:179], 0
K12B_nocs0:
  s_waitcnt lgkmcnt(0)
  v_mfma_f32_32x32x16_bf16 v[0:15], v[208:211], v[180:183], v[0:15]
  s_waitcnt vmcnt(11)
  s_barrier
  s_add_u32 m0, s52, 0
  s_nop 0
  buffer_load_dwordx4 v239, s[48:51], s75 offen lds
  v_mfma_f32_32x32x16_bf16 v[16:31], v[212:215], v[180:183], v[16:31]
  ds_read_b128 v[200:203], v223 offset:0
  ds_read_b128 v[204:207], v223 offset:4096
  s_add_u32 s44, s44, 128
  s_and_b32 s44, s44, 1023
  s_add_u32 s59, s47, s44
  v_mfma_f32_32x32x16_bf16 v[32:47], v[208:211], v[184:187], v[32:47]
  ds_read_b64_tr_b16 v[160:161], v216 offset:20480
  s_add_u32 m0, s46, 32768
  ds_read_b64_tr_b16 v[162:163], v216 offset:20992
  buffer_load_dwordx4 v230, s[4:7], s59 offen lds
  v_mfma_f32_32x32x16_bf16 v[48:63], v[212:215], v[184:187], v[48:63]
  ds_read_b64_tr_b16 v[164:165], v217 offset:20480
  s_add_u32 m0, s46, 33792
  ds_read_b64_tr_b16 v[166:167], v217 offset:20992
  buffer_load_dwordx4 v231, s[4:7], s59 offen lds
  v_mfma_f32_32x32x16_bf16 v[64:79], v[188:191], v[208:211], v[64:79]
  ds_read_b64_tr_b16 v[168:169], v218 offset:20480
  s_add_u32 m0, s46, 34816
  ds_read_b64_tr_b16 v[170:171], v218 offset:20992
  buffer_load_dwordx4 v232, s[4:7], s59 offen lds
  v_mfma_f32_32x32x16_bf16 v[80:95], v[188:191], v[212:215], v[80:95]
  ds_read_b64_tr_b16 v[172:173], v219 offset:20480
  s_add_u32 m0, s46, 35840
  ds_read_b64_tr_b16 v[174:175], v219 offset:20992
  buffer_load_dwordx4 v233, s[4:7], s59 offen lds
  v_mfma_f32_32x32x16_bf16 v[96:111], v[192:195], v[208:211], v[96:111]
  ds_read_b64_tr_b16 v[176:177], v220 offset:20480
  ds_read_b64_tr_b16 v[178:179], v220 offset:20736
  s_add_u32 s39, s39, 32
  s_and_b32 s39, s39, 511
  v_mfma_f32_32x32x16_bf16 v[112:127], v[192:195], v[212:215], v[112:127]
  s_add_u32 s40, s40, 32
  s_and_b32 s40, s40, 511
  s_mul_i32 s41, s39, 3072
  s_mul_i32 s42, s39, 3584
  s_mul_i32 s43, s40, 3584
  v_mfma_f32_32x32x16_bf16 v[128:143], v[196:199], v[208:211], v[128:143]
  s_add_u32 m0, s45, 49152
  s_nop 0
  buffer_load_dwordx4 v225, s[8:11], s41 offen lds
  s_add_u32 m0, s52, 1024
  s_nop 0
  buffer_load_dwordx4 v226, s[48:51], s75 offen lds
  v_mfma_f32_32x32x16_bf16 v[144:159], v[196:199], v[212:215], v[144:159]
  s_cmp_eq_u32 s66, 1
  s_cbranch_scc0 K12B_nocs1
  v_mfma_f32_32x32x16_bf16 a[140:155], a[220:223], v[180:183], 0
  v_mfma_f32_32x32x16_bf16 a[156:171], a[220:223], v[184:187], 0
  v_mfma_f32_32x32x16_bf16 a[172:187], a[220:223], v[188:191], 0
  v_mfma_f32_32x32x16_bf16 a[188:203], a[220:223], v[192:195], 0
  v_mfma_f32_32x32x16_bf16 a[204:219], a[220:223], v[196:199], 0
K12B_nocs1:
  s_waitcnt lgkmcnt(0)
  v_mfma_f32_32x32x16_bf16 v[0:15], v[200:203], v[160:163], v[0:15]
  ds_read_b128 v[208:211], v224 offset:0
  s_add_u32 m0, s45, 53248
  ds_read_b128 v[212:215], v224 offset:4096
  buffer_load_dwordx4 v225, s[12:15], s41 offen lds
  v_mfma_f32_32x32x16_bf16 v[16:31], v[204:207], v[160:163], v[16:31]
  ds_read_b64_tr_b16 v[180:181], v216 offset:22528
  s_add_u32 m0, s45, 57344
  ds_read_b64_tr_b16 v[182:183], v216 offset:23040
  buffer_load_dwordx4 v227, s[16:19], s42 offen lds
  v_mfma_f32_32x32x16_bf16 v[32:47], v[200:203], v[164:167], v[32:47]
  ds_read_b64_tr_b16 v[184:185], v217 offset:22528
  s_add_u32 m0, s45, 61440
  ds_read_b64_tr_b16 v[186:187], v217 offset:23040
  buffer_load_dwordx4 v228, s[20:23], s42 offen lds
  v_mfma_f32_32x32x16_bf16 v[48:63], v[204:207], v[164:167], v[48:63]
  ds_read_b64_tr_b16 v[188:189], v218 offset:22528
  s_add_u32 m0, s45, 65536
  ds_read_b64_tr_b16 v[190:191], v218 offset:23040
  buffer_load_dwordx4 v229, s[24:27], s43 offen lds
  v_mfma_f32_32x32x16_bf16 v[64:79], v[168:171], v[200:203], v[64:79]
  ds_read_b64_tr_b16 v[192:193], v219 offset:22528
  ds_read_b64_tr_b16 v[194:195], v219 offset:23040
  s_add_u32 s75, s75, 16384
  s_cmp_eq_u32 s75, 458752
  s_cselect_b32 s75, 0, s75
  v_mfma_f32_32x32x16_bf16 v[80:95], v[168:171], v[204:207], v[80:95]
  ds_read_b64_tr_b16 v[196:197], v220 offset:21504
  s_add_u32 m0, s52, 2048
  ds_read_b64_tr_b16 v[198:199], v220 offset:21760
  buffer_load_dwordx4 v239, s[48:51], s75 offen lds
  v_mfma_f32_32x32x16_bf16 v[96:111], v[172:175], v[200:203], v[96:111]
  s_add_u32 m0, s52, 3072
  s_nop 0
  buffer_load_dwordx4 v226, s[48:51], s75 offen lds
  v_mfma_f32_32x32x16_bf16 v[112:127], v[172:175], v[204:207], v[112:127]
  s_add_u32 s75, s75, 16384
  s_cmp_eq_u32 s75, 458752
  s_cselect_b32 s75, 0, s75
  v_mfma_f32_32x32x16_bf16 v[128:143], v[176:179], v[200:203], v[128:143]
  v_mfma_f32_32x32x16_bf16 v[144:159], v[176:179], v[204:207], v[144:159]
  s_cmp_eq_u32 s66, 2
  s_cbranch_scc0 K12B_nocs2
  v_mfma_f32_32x32x16_bf16 a[140:155], a[220:223], v[160:163], 0
  v_mfma_f32_32x32x16_bf16 a[156:171], a[220:223], v[164:167], 0
  v_mfma_f32_32x32x16_bf16 a[172:187], a[220:223], v[168:171], 0
  v_mfma_f32_32x32x16_bf16 a[188:203], a[220:223], v[172:175], 0
  v_mfma_f32_32x32x16_bf16 a[204:219], a[220:223], v[176:179], 0
K12B_nocs2:
  s_cmp_eq_u32 s34, 0
  s_cbranch_scc0 K12B_w0_initld
  v_mov_b32 v249, 0
  s_mov_b64 s[60:61], exec
  s_mov_b64 exec, 1
  global_load_dword v250, v249, s[72:73] sc1
  s_mov_b64 exec, s[60:61]
K12B_w0_initld:
  s_waitcnt lgkmcnt(0)
  v_mfma_f32_32x32x16_bf16 v[0:15], v[208:211], v[180:183], v[0:15]
  s_waitcnt vmcnt(13)
  s_barrier
  s_add_u32 m0, s52, 4096
  s_nop 0
  buffer_load_dwordx4 v239, s[48:51], s75 offen lds
  v_mfma_f32_32x32x16_bf16 v[16:31], v[212:215], v[180:183], v[16:31]
  ds_read_b128 v[200:203], v221 offset:16384
  ds_read_b128 v[204:207], v221 offset:20480
  s_add_u32 s39, s39, 32
  s_and_b32 s39, s39, 511
  v_mfma_f32_32x32x16_bf16 v[32:47], v[208:211], v[184:187], v[32:47]
  ds_read_b64_tr_b16 v[160:161], v216 offset:40960
  ds_read_b64_tr_b16 v[162:163], v216 offset:41472
  s_add_u32 s40, s40, 32
  s_and_b32 s40, s40, 511
  v_mfma_f32_32x32x16_bf16 v[48:63], v[212:215], v[184:187], v[48:63]
  ds_read_b64_tr_b16 v[164:165], v217 offset:40960
  ds_read_b64_tr_b16 v[166:167], v217 offset:41472
  s_mul_i32 s41, s39, 3072
  s_mul_i32 s42, s39, 3584
  s_mul_i32 s43, s40, 3584
  v_mfma_f32_32x32x16_bf16 v[64:79], v[188:191], v[208:211], v[64:79]
  ds_read_b64_tr_b16 v[168:169], v218 offset:40960
  s_add_u32 m0, s45, 69632
  ds_read_b64_tr_b16 v[170:171], v218 offset:41472
  buffer_load_dwordx4 v225, s[8:11], s41 offen lds
  v_mfma_f32_32x32x16_bf16 v[80:95], v[188:191], v[212:215], v[80:95]
  ds_read_b64_tr_b16 v[172:173], v219 offset:40960
  s_add_u32 m0, s45, 73728
  ds_read_b64_tr_b16 v[174:175], v219 offset:41472
  buffer_load_dwordx4 v225, s[12:15], s41 offen lds
  v_mfma_f32_32x32x16_bf16 v[96:111], v[192:195], v[208:211], v[96:111]
  ds_read_b64_tr_b16 v[176:177], v220 offset:40960
  s_add_u32 m0, s45, 77824
  ds_read_b64_tr_b16 v[178:179], v220 offset:41216
  buffer_load_dwordx4 v227, s[16:19], s42 offen lds
  v_mfma_f32_32x32x16_bf16 v[112:127], v[192:195], v[212:215], v[112:127]
  s_add_u32 m0, s45, 81920
  s_nop 0
  buffer_load_dwordx4 v228, s[20:23], s42 offen lds
  s_add_u32 m0, s52, 5120
  s_nop 0
  buffer_load_dwordx4 v226, s[48:51], s75 offen lds
  v_mfma_f32_32x32x16_bf16 v[128:143], v[196:199], v[208:211], v[128:143]
  s_add_u32 m0, s45, 86016
  s_nop 0
  buffer_load_dwordx4 v229, s[24:27], s43 offen lds
  v_mfma_f32_32x32x16_bf16 v[144:159], v[196:199], v[212:215], v[144:159]
  s_cmp_eq_u32 s66, 3
  s_cbranch_scc0 K12B_nocs3
  v_mfma_f32_32x32x16_bf16 a[140:155], a[220:223], v[180:183], 0
  v_mfma_f32_32x32x16_bf16 a[156:171], a[220:223], v[184:187], 0
  v_mfma_f32_32x32x16_bf16 a[172:187], a[220:223], v[188:191], 0
  v_mfma_f32_32x32x16_bf16 a[188:203], a[220:223], v[192:195], 0
  v_mfma_f32_32x32x16_bf16 a[204:219], a[220:223], v[196:199], 0
K12B_nocs3:
  s_waitcnt lgkmcnt(0)
  v_mfma_f32_32x32x16_bf16 v[0:15], v[200:203], v[160:163], v[0:15]
  ds_read_b128 v[208:211], v222 offset:16384
  ds_read_b128 v[212:215], v222 offset:20480
  s_add_u32 s44, s44, 128
  s_and_b32 s44, s44, 1023
  s_add_u32 s59, s47, s44
  v_mfma_f32_32x32x16_bf16 v[16:31], v[204:207], v[160:163], v[16:31]
  ds_read_b64_tr_b16 v[180:181], v216 offset:43008
  s_add_u32 m0, s46, 0
  ds_read_b64_tr_b16 v[182:183], v216 offset:43520
  buffer_load_dwordx4 v230, s[4:7], s59 offen lds
  v_mfma_f32_32x32x16_bf16 v[32:47], v[200:203], v[164:167], v[32:47]
  ds_read_b64_tr_b16 v[184:185], v217 offset:43008
  s_add_u32 m0, s46, 1024
  ds_read_b64_tr_b16 v[186:187], v217 offset:43520
  buffer_load_dwordx4 v231, s[4:7], s59 offen lds
  v_mfma_f32_32x32x16_bf16 v[48:63], v[204:207], v[164:167], v[48:63]
  ds_read_b64_tr_b16 v[188:189], v218 offset:43008
  s_add_u32 m0, s46, 2048
  ds_read_b64_tr_b16 v[190:191], v218 offset:43520
  buffer_load_dwordx4 v232, s[4:7], s59 offen lds
  v_mfma_f32_32x32x16_bf16 v[64:79], v[168:171], v[200:203], v[64:79]
  ds_read_b64_tr_b16 v[192:193], v219 offset:43008
  s_add_u32 m0, s46, 3072
  ds_read_b64_tr_b16 v[194:195], v219 offset:43520
  buffer_load_dwordx4 v233, s[4:7], s59 offen lds
  v_mfma_f32_32x32x16_bf16 v[80:95], v[168:171], v[204:207], v[80:95]
  ds_read_b64_tr_b16 v[196:197], v220 offset:41984
  ds_read_b64_tr_b16 v[198:199], v220 offset:42240
  s_add_u32 s75, s75, 16384
  s_cmp_eq_u32 s75, 458752
  s_cselect_b32 s75, 0, s75
  v_mfma_f32_32x32x16_bf16 v[96:111], v[172:175], v[200:203], v[96:111]
  s_add_u32 m0, s52, 6144
  s_nop 0
  buffer_load_dwordx4 v239, s[48:51], s75 offen lds
  v_mfma_f32_32x32x16_bf16 v[112:127], v[172:175], v[204:207], v[112:127]
  s_add_u32 m0, s52, 7168
  s_nop 0
  buffer_load_dwordx4 v226, s[48:51], s75 offen lds
  v_mfma_f32_32x32x16_bf16 v[128:143], v[176:179], v[200:203], v[128:143]
  s_add_u32 s75, s75, 16384
  s_cmp_eq_u32 s75, 458752
  s_cselect_b32 s75, 0, s75
  v_mfma_f32_32x32x16_bf16 v[144:159], v[176:179], v[204:207], v[144:159]
  s_waitcnt lgkmcnt(0)
  v_mfma_f32_32x32x16_bf16 v[0:15], v[208:211], v[180:183], v[0:15]
  s_cmp_eq_u32 s34, 0
  s_cbranch_scc0 K12B_w0_initchk
  s_waitcnt vmcnt(13)
  v_readfirstlane_b32 s58, v250
  s_nop 0
  s_cmp_ge_u32 s58, 18
  s_cbranch_scc1 K12B_initok
  v_mov_b32 v249, 0
  s_mov_b32 s57, 0
K12B_spin_init:
  global_load_dword v250, v249, s[72:73] sc1
  s_waitcnt vmcnt(0)
  v_readfirstlane_b32 s58, v250
  s_add_u32 s57, s57, 1
  s_cmp_ge_u32 s57, 200000
  s_cbranch_scc1 K12B_spin_init_x
  s_cmp_ge_u32 s58, 18
  s_cbranch_scc1 K12B_spin_init_x
  s_sleep 2
  s_branch K12B_spin_init
K12B_spin_init_x:
K12B_initok:
K12B_w0_initchk:
  s_waitcnt vmcnt(15)
  s_barrier
  s_cmp_eq_u32 s34, 0
  s_cbranch_scc0 K12B_sig_st
  s_lshl_b32 s58, s37, 7
  s_add_u32 s58, s58, 100352
  v_mov_b32 v249, s58
  v_mov_b32 v248, 1
  s_mov_b64 s[60:61], exec
  s_mov_b64 exec, 1
  global_atomic_add v249, v248, s[32:33] sc1
  s_mov_b64 exec, s[60:61]
K12B_sig_st:
  v_mfma_f32_32x32x16_bf16 v[16:31], v[212:215], v[180:183], v[16:31]
  ds_read_b128 v[200:203], v223 offset:16384
  ds_read_b128 v[204:207], v223 offset:20480
  s_add_u32 s39, s39, 32
  s_and_b32 s39, s39, 511
  v_mfma_f32_32x32x16_bf16 v[32:47], v[208:211], v[184:187], v[32:47]
  ds_read_b64_tr_b16 v[160:161], v216 offset:0
  ds_read_b64_tr_b16 v[162:163], v216 offset:512
  s_add_u32 s40, s40, 32
  s_and_b32 s40, s40, 511
  v_mfma_f32_32x32x16_bf16 v[48:63], v[212:215], v[184:187], v[48:63]
  ds_read_b64_tr_b16 v[164:165], v217 offset:0
  ds_read_b64_tr_b16 v[166:167], v217 offset:512
  s_mul_i32 s41, s39, 3072
  s_mul_i32 s42, s39, 3584
  s_mul_i32 s43, s40, 3584
  v_mfma_f32_32x32x16_bf16 v[64:79], v[188:191], v[208:211], v[64:79]
  ds_read_b64_tr_b16 v[168:169], v218 offset:0
  s_add_u32 m0, s45, 90112
  ds_read_b64_tr_b16 v[170:171], v218 offset:512
  buffer_load_dwordx4 v225, s[8:11], s41 offen lds
  v_mfma_f32_32x32x16_bf16 v[80:95], v[188:191], v[212:215], v[80:95]
  ds_read_b64_tr_b16 v[172:173], v219 offset:0
  s_add_u32 m0, s45, 94208
  ds_read_b64_tr_b16 v[174:175], v219 offset:512
  buffer_load_dwordx4 v225, s[12:15], s41 offen lds
  v_mfma_f32_32x32x16_bf16 v[96:111], v[192:195], v[208:211], v[96:111]
  ds_read_b64_tr_b16 v[176:177], v220 offset:0
  s_add_u32 m0, s45, 98304
  ds_read_b64_tr_b16 v[178:179], v220 offset:256
  buffer_load_dwordx4 v227, s[16:19], s42 offen lds
  v_mfma_f32_32x32x16_bf16 v[112:127], v[192:195], v[212:215], v[112:127]
  s_add_u32 m0, s45, 102400
  s_nop 0
  buffer_load_dwordx4 v228, s[20:23], s42 offen lds
  s_add_u32 m0, s52, 8192
  s_nop 0
  buffer_load_dwordx4 v239, s[48:51], s75 offen lds
  v_mfma_f32_32x32x16_bf16 v[128:143], v[196:199], v[208:211], v[128:143]
  s_add_u32 m0, s45, 106496
  s_nop 0
  buffer_load_dwordx4 v229, s[24:27], s43 offen lds
  s_add_u32 m0, s52, 9216
  s_nop 0
  buffer_load_dwordx4 v226, s[48:51], s75 offen lds
  v_mfma_f32_32x32x16_bf16 v[144:159], v[196:199], v[212:215], v[144:159]
  s_add_u32 s75, s75, 16384
  s_cmp_eq_u32 s75, 458752
  s_cselect_b32 s75, 0, s75
  s_waitcnt lgkmcnt(0)
  v_mfma_f32_32x32x16_bf16 v[0:15], v[200:203], v[160:163], v[0:15]
  ds_read_b128 v[208:211], v224 offset:16384
  ds_read_b128 v[212:215], v224 offset:20480
  v_accvgpr_read_b32 v240, a140
  v_accvgpr_read_b32 v241, a156
  v_accvgpr_read_b32 v242, a172
  v_mfma_f32_32x32x16_bf16 v[16:31], v[204:207], v[160:163], v[16:31]
  ds_read_b64_tr_b16 v[180:181], v216 offset:2048
  ds_read_b64_tr_b16 v[182:183], v216 offset:2560
  v_accvgpr_read_b32 v243, a188
  v_accvgpr_read_b32 v244, a204
  s_waitcnt vmcnt(26)
  v_mfma_f32_32x32x16_bf16 v[32:47], v[200:203], v[164:167], v[32:47]
  ds_read_b64_tr_b16 v[184:185], v217 offset:2048
  ds_read_b64_tr_b16 v[186:187], v217 offset:2560
  ds_read_b64_tr_b16 a[0:1], v254 offset:0
  ds_read_b64_tr_b16 a[2:3], v254 offset:1024
  v_mfma_f32_32x32x16_bf16 v[48:63], v[204:207], v[164:167], v[48:63]
  ds_read_b64_tr_b16 v[188:189], v218 offset:2048
  ds_read_b64_tr_b16 v[190:191], v218 offset:2560
  ds_read_b64_tr_b16 a[4:5], v255 offset:0
  ds_read_b64_tr_b16 a[6:7], v255 offset:1024
  v_mfma_f32_32x32x16_bf16 v[64:79], v[168:171], v[200:203], v[64:79]
  ds_read_b64_tr_b16 v[192:193], v219 offset:2048
  s_add_u32 m0, s52, 10240
  ds_read_b64_tr_b16 v[194:195], v219 offset:2560
  buffer_load_dwordx4 v239, s[48:51], s75 offen lds
  v_mfma_f32_32x32x16_bf16 v[80:95], v[168:171], v[204:207], v[80:95]
  ds_read_b64_tr_b16 v[196:197], v220 offset:1024
  s_add_u32 m0, s52, 11264
  ds_read_b64_tr_b16 v[198:199], v220 offset:1280
  buffer_load_dwordx4 v226, s[48:51], s75 offen lds
  v_mfma_f32_32x32x16_bf16 v[96:111], v[172:175], v[200:203], v[96:111]
  s_mov_b64 s[60:61], exec
  s_mov_b32 exec_hi, 0
  global_atomic_add_f32 v252, v240, s[32:33] offset:0
  global_atomic_add_f32 v252, v241, s[32:33] offset:2048
  global_atomic_add_f32 v251, v242, s[32:33] offset:0
  global_atomic_add_f32 v251, v243, s[32:33] offset:64
  global_atomic_add_f32 v253, v244, s[32:33] offset:0
  s_mov_b64 exec, s[60:61]
  v_mfma_f32_32x32x16_bf16 v[112:127], v[172:175], v[204:207], v[112:127]
  s_add_u32 s75, s75, 16384
  s_cmp_eq_u32 s75, 458752
  s_cselect_b32 s75, 0, s75
  v_mfma_f32_32x32x16_bf16 v[128:143], v[176:179], v[200:203], v[128:143]
  v_mfma_f32_32x32x16_bf16 v[144:159], v[176:179], v[204:207], v[144:159]
  s_waitcnt lgkmcnt(0)
  v_mfma_f32_32x32x16_bf16 v[0:15], v[208:211], v[180:183], v[0:15]
  s_waitcnt vmcnt(20)
  s_barrier
  s_waitcnt vmcnt(27)
  ds_read_b64_tr_b16 a[8:9], v254 offset:2048
  ds_read_b64_tr_b16 a[10:11], v254 offset:3072
  v_mfma_f32_32x32x16_bf16 v[16:31], v[212:215], v[180:183], v[16:31]
  ds_read_b128 v[200:203], v221 offset:32768
  ds_read_b128 v[204:207], v221 offset:36864
  s_add_u32 s39, s39, 32
  s_and_b32 s39, s39, 511
  v_mfma_f32_32x32x16_bf16 v[32:47], v[208:211], v[184:187], v[32:47]
  ds_read_b64_tr_b16 v[160:161], v216 offset:20480
  ds_read_b64_tr_b16 v[162:163], v216 offset:20992
  s_add_u32 s40, s40, 32
  s_and_b32 s40, s40, 511
  v_mfma_f32_32x32x16_bf16 v[48:63], v[212:215], v[184:187], v[48:63]
  ds_read_b64_tr_b16 v[164:165], v217 offset:20480
  ds_read_b64_tr_b16 v[166:167], v217 offset:20992
  s_mul_i32 s41, s39, 3072
  s_mul_i32 s42, s39, 3584
  s_mul_i32 s43, s40, 3584
  v_mfma_f32_32x32x16_bf16 v[64:79], v[188:191], v[208:211], v[64:79]
  ds_read_b64_tr_b16 v[168:169], v218 offset:20480
  s_add_u32 m0, s45, 49152
  ds_read_b64_tr_b16 v[170:171], v218 offset:20992
  buffer_load_dwordx4 v225, s[8:11], s41 offen lds
  v_mfma_f32_32x32x16_bf16 v[80:95], v[188:191], v[212:215], v[80:95]
  ds_read_b64_tr_b16 v[172:173], v219 offset:20480
  s_add_u32 m0, s45, 53248
  ds_read_b64_tr_b16 v[174:175], v219 offset:20992
  buffer_load_dwordx4 v225, s[12:15], s41 offen lds
  v_mfma_f32_32x32x16_bf16 v[96:111], v[192:195], v[208:211], v[96:111]
  ds_read_b64_tr_b16 v[176:177], v220 offset:20480
  s_add_u32 m0, s45, 57344
  ds_read_b64_tr_b16 v[178:179], v220 offset:20736
  buffer_load_dwordx4 v227, s[16:19], s42 offen lds
  v_mfma_f32_32x32x16_bf16 v[112:127], v[192:195], v[212:215], v[112:127]
  s_add_u32 m0, s45, 61440
  s_nop 0
  buffer_load_dwordx4 v228, s[20:23], s42 offen lds
  ds_read_b64_tr_b16 a[12:13], v255 offset:2048
  ds_read_b64_tr_b16 a[14:15], v255 offset:3072
  v_mfma_f32_32x32x16_bf16 v[128:143], v[196:199], v[208:211], v[128:143]
  s_add_u32 m0, s45, 65536
  s_nop 0
  buffer_load_dwordx4 v229, s[24:27], s43 offen lds
  s_add_u32 m0, s52, 0
  s_nop 0
  buffer_load_dwordx4 v239, s[48:51], s75 offen lds
  v_mfma_f32_32x32x16_bf16 v[144:159], v[196:199], v[212:215], v[144:159]
  s_add_u32 s44, s44, 128
  s_and_b32 s44, s44, 1023
  s_add_u32 s59, s47, s44
  s_add_u32 m0, s46, 16384
  s_nop 0
  buffer_load_dwordx4 v230, s[4:7], s59 offen lds
  s_waitcnt lgkmcnt(0)
  v_mfma_f32_32x32x16_bf16 v[0:15], v[200:203], v[160:163], v[0:15]
  ds_read_b128 v[208:211], v222 offset:32768
  s_add_u32 m0, s46, 17408
  ds_read_b128 v[212:215], v222 offset:36864
  buffer_load_dwordx4 v231, s[4:7], s59 offen lds
  v_mfma_f32_32x32x16_bf16 v[16:31], v[204:207], v[160:163], v[16:31]
  ds_read_b64_tr_b16 v[180:181], v216 offset:22528
  s_add_u32 m0, s46, 18432
  ds_read_b64_tr_b16 v[182:183], v216 offset:23040
  buffer_load_dwordx4 v232, s[4:7], s59 offen lds
  v_mfma_f32_32x32x16_bf16 v[32:47], v[200:203], v[164:167], v[32:47]
  ds_read_b64_tr_b16 v[184:185], v217 offset:22528
  s_add_u32 m0, s46, 19456
  ds_read_b64_tr_b16 v[186:187], v217 offset:23040
  buffer_load_dwordx4 v233, s[4:7], s59 offen lds
  v_mfma_f32_32x32x16_bf16 v[48:63], v[204:207], v[164:167], v[48:63]
  ds_read_b64_tr_b16 v[188:189], v218 offset:22528
  s_add_u32 m0, s52, 1024
  ds_read_b64_tr_b16 v[190:191], v218 offset:23040
  buffer_load_dwordx4 v226, s[48:51], s75 offen lds
  v_mfma_f32_32x32x16_bf16 v[64:79], v[168:171], v[200:203], v[64:79]
  ds_read_b64_tr_b16 v[192:193], v219 offset:22528
  ds_read_b64_tr_b16 v[194:195], v219 offset:23040
  s_add_u32 s75, s75, 16384
  s_cmp_eq_u32 s75, 458752
  s_cselect_b32 s75, 0, s75
  v_mfma_f32_32x32x16_bf16 v[80:95], v[168:171], v[204:207], v[80:95]
  ds_read_b64_tr_b16 v[196:197], v220 offset:21504
  ds_read_b64_tr_b16 v[198:199], v220 offset:21760
  s_waitcnt vmcnt(32)
  ds_read_b64_tr_b16 a[16:17], v254 offset:4096
  ds_read_b64_tr_b16 a[18:19], v254 offset:5120
  v_mfma_f32_32x32x16_bf16 v[96:111], v[172:175], v[200:203], v[96:111]
  ds_read_b64_tr_b16 a[20:21], v255 offset:4096
  s_add_u32 m0, s52, 2048
  ds_read_b64_tr_b16 a[22:23], v255 offset:5120
  buffer_load_dwordx4 v239, s[48:51], s75 offen lds
  v_mfma_f32_32x32x16_bf16 v[112:127], v[172:175], v[204:207], v[112:127]
  s_add_u32 m0, s52, 3072
  s_nop 0
  buffer_load_dwordx4 v226, s[48:51], s75 offen lds
  v_mfma_f32_32x32x16_bf16 v[128:143], v[176:179], v[200:203], v[128:143]
  s_add_u32 s75, s75, 16384
  s_cmp_eq_u32 s75, 458752
  s_cselect_b32 s75, 0, s75
  v_mfma_f32_32x32x16_bf16 v[144:159], v[176:179], v[204:207], v[144:159]
  s_waitcnt lgkmcnt(0)
  v_mfma_f32_32x32x16_bf16 v[0:15], v[208:211], v[180:183], v[0:15]
  s_waitcnt vmcnt(21)
  s_barrier
  s_waitcnt vmcnt(27)
  ds_read_b64_tr_b16 a[24:25], v254 offset:6144
  ds_read_b64_tr_b16 a[26:27], v254 offset:7168
  v_mfma_f32_32x32x16_bf16 v[16:31], v[212:215], v[180:183], v[16:31]
  ds_read_b128 v[200:203], v223 offset:32768
  ds_read_b128 v[204:207], v223 offset:36864
  s_add_u32 s39, s39, 32
  s_and_b32 s39, s39, 511
  v_mfma_f32_32x32x16_bf16 v[32:47], v[208:211], v[184:187], v[32:47]
  ds_read_b64_tr_b16 v[160:161], v216 offset:40960
  ds_read_b64_tr_b16 v[162:163], v216 offset:41472
  s_add_u32 s40, s40, 32
  s_and_b32 s40, s40, 511
  v_mfma_f32_32x32x16_bf16 v[48:63], v[212:215], v[184:187], v[48:63]
  ds_read_b64_tr_b16 v[164:165], v217 offset:40960
  ds_read_b64_tr_b16 v[166:167], v217 offset:41472
  s_mul_i32 s41, s39, 3072
  s_mul_i32 s42, s39, 3584
  s_mul_i32 s43, s40, 3584
  v_mfma_f32_32x32x16_bf16 v[64:79], v[188:191], v[208:211], v[64:79]
  ds_read_b64_tr_b16 v[168:169], v218 offset:40960
  s_add_u32 m0, s45, 69632
  ds_read_b64_tr_b16 v[170:171], v218 offset:41472
  buffer_load_dwordx4 v225, s[8:11], s41 offen lds
  v_mfma_f32_32x32x16_bf16 v[80:95], v[188:191], v[212:215], v[80:95]
  ds_read_b64_tr_b16 v[172:173], v219 offset:40960
  s_add_u32 m0, s45, 73728
  ds_read_b64_tr_b16 v[174:175], v219 offset:41472
  buffer_load_dwordx4 v225, s[12:15], s41 offen lds
  v_mfma_f32_32x32x16_bf16 v[96:111], v[192:195], v[208:211], v[96:111]
  ds_read_b64_tr_b16 v[176:177], v220 offset:40960
  s_add_u32 m0, s45, 77824
  ds_read_b64_tr_b16 v[178:179], v220 offset:41216
  buffer_load_dwordx4 v227, s[16:19], s42 offen lds
  v_mfma_f32_32x32x16_bf16 v[112:127], v[192:195], v[212:215], v[112:127]
  s_add_u32 m0, s45, 81920
  s_nop 0
  buffer_load_dwordx4 v228, s[20:23], s42 offen lds
  ds_read_b64_tr_b16 a[28:29], v255 offset:6144
  ds_read_b64_tr_b16 a[30:31], v255 offset:7168
  v_mfma_f32_32x32x16_bf16 v[128:143], v[196:199], v[208:211], v[128:143]
  s_add_u32 m0, s45, 86016
  s_nop 0
  buffer_load_dwordx4 v229, s[24:27], s43 offen lds
  s_add_u32 m0, s52, 4096
  s_nop 0
  buffer_load_dwordx4 v239, s[48:51], s75 offen lds
  v_mfma_f32_32x32x16_bf16 v[144:159], v[196:199], v[212:215], v[144:159]
  s_add_u32 m0, s52, 5120
  s_nop 0
  buffer_load_dwordx4 v226, s[48:51], s75 offen lds
  s_waitcnt lgkmcnt(0)
  v_mfma_f32_32x32x16_bf16 v[0:15], v[200:203], v[160:163], v[0:15]
  ds_read_b128 v[208:211], v224 offset:32768
  ds_read_b128 v[212:215], v224 offset:36864
  s_add_u32 s75, s75, 16384
  s_cmp_eq_u32 s75, 458752
  s_cselect_b32 s75, 0, s75
  v_mfma_f32_32x32x16_bf16 v[16:31], v[204:207], v[160:163], v[16:31]
  ds_read_b64_tr_b16 v[180:181], v216 offset:43008
  ds_read_b64_tr_b16 v[182:183], v216 offset:43520
  s_waitcnt vmcnt(27)
  ds_read_b64_tr_b16 a[32:33], v254 offset:8192
  ds_read_b64_tr_b16 a[34:35], v254 offset:9216
  v_mfma_f32_32x32x16_bf16 v[32:47], v[200:203], v[164:167], v[32:47]
  ds_read_b64_tr_b16 v[184:185], v217 offset:43008
  ds_read_b64_tr_b16 v[186:187], v217 offset:43520
  ds_read_b64_tr_b16 a[36:37], v255 offset:8192
  ds_read_b64_tr_b16 a[38:39], v255 offset:9216
  v_mfma_f32_32x32x16_bf16 v[48:63], v[204:207], v[164:167], v[48:63]
  ds_read_b64_tr_b16 v[188:189], v218 offset:43008
  s_add_u32 m0, s52, 6144
  ds_read_b64_tr_b16 v[190:191], v218 offset:43520
  buffer_load_dwordx4 v239, s[48:51], s75 offen lds
  v_mfma_f32_32x32x16_bf16 v[64:79], v[168:171], v[200:203], v[64:79]
  ds_read_b64_tr_b16 v[192:193], v219 offset:43008
  s_add_u32 m0, s52, 7168
  ds_read_b64_tr_b16 v[194:195], v219 offset:43520
  buffer_load_dwordx4 v226, s[48:51], s75 offen lds
  v_mfma_f32_32x32x16_bf16 v[80:95], v[168:171], v[204:207], v[80:95]
  ds_read_b64_tr_b16 v[196:197], v220 offset:41984
  ds_read_b64_tr_b16 v[198:199], v220 offset:42240
  s_add_u32 s75, s75, 16384
  s_cmp_eq_u32 s75, 458752
  s_cselect_b32 s75, 0, s75
  v_mfma_f32_32x32x16_bf16 v[96:111], v[172:175], v[200:203], v[96:111]
  v_mfma_f32_32x32x16_bf16 v[112:127], v[172:175], v[204:207], v[112:127]
  v_mfma_f32_32x32x16_bf16 v[128:143], v[176:179], v[200:203], v[128:143]
  v_mfma_f32_32x32x16_bf16 v[144:159], v[176:179], v[204:207], v[144:159]
  s_waitcnt lgkmcnt(0)
  v_mfma_f32_32x32x16_bf16 v[0:15], v[208:211], v[180:183], v[0:15]
  s_waitcnt vmcnt(17)
  s_barrier
  s_cmp_eq_u32 s34, 0
  s_cbranch_scc0 K12B_sig_cs
  s_lshl_b32 s58, s67, 7
  s_add_u32 s58, s58, 102400
  v_mov_b32 v249, s58
  v_mov_b32 v248, 1
  s_mov_b64 s[60:61], exec
  s_mov_b64 exec, 1
  global_atomic_add v249, v248, s[32:33] sc1
  s_mov_b64 exec, s[60:61]
K12B_sig_cs:
  v_mfma_f32_32x32x16_bf16 v[16:31], v[212:215], v[180:183], v[16:31]
  ds_read_b128 v[200:203], v221 offset:0
  ds_read_b128 v[204:207], v221 offset:4096
  s_add_u32 s39, s39, 32
  s_and_b32 s39, s39, 511
  s_waitcnt vmcnt(27)
  v_mfma_f32_32x32x16_bf16 v[32:47], v[208:211], v[184:187], v[32:47]
  ds_read_b64_tr_b16 v[160:161], v216 offset:0
  ds_read_b64_tr_b16 v[162:163], v216 offset:512
  s_add_u32 s40, s40, 32
  s_and_b32 s40, s40, 511
  v_mfma_f32_32x32x16_bf16 v[48:63], v[212:215], v[184:187], v[48:63]
  ds_read_b64_tr_b16 v[164:165], v217 offset:0
  ds_read_b64_tr_b16 v[166:167], v217 offset:512
  s_mul_i32 s41, s39, 3072
  s_mul_i32 s42, s39, 3584
  s_mul_i32 s43, s40, 3584
  v_mfma_f32_32x32x16_bf16 v[64:79], v[188:191], v[208:211], v[64:79]
  ds_read_b64_tr_b16 v[168:169], v218 offset:0
  s_add_u32 m0, s45, 90112
  ds_read_b64_tr_b16 v[170:171], v218 offset:512
  buffer_load_dwordx4 v225, s[8:11], s41 offen lds
  v_mfma_f32_32x32x16_bf16 v[80:95], v[188:191], v[212:215], v[80:95]
  ds_read_b64_tr_b16 v[172:173], v219 offset:0
  s_add_u32 m0, s45, 94208
  ds_read_b64_tr_b16 v[174:175], v219 offset:512
  buffer_load_dwordx4 v225, s[12:15], s41 offen lds
  v_mfma_f32_32x32x16_bf16 v[96:111], v[192:195], v[208:211], v[96:111]
  ds_read_b64_tr_b16 v[176:177], v220 offset:0
  s_add_u32 m0, s45, 98304
  ds_read_b64_tr_b16 v[178:179], v220 offset:256
  buffer_load_dwordx4 v227, s[16:19], s42 offen lds
  v_mfma_f32_32x32x16_bf16 v[112:127], v[192:195], v[212:215], v[112:127]
  s_add_u32 m0, s45, 102400
  s_nop 0
  buffer_load_dwordx4 v228, s[20:23], s42 offen lds
  ds_read_b64_tr_b16 a[40:41], v254 offset:10240
  ds_read_b64_tr_b16 a[42:43], v254 offset:11264
  v_mfma_f32_32x32x16_bf16 v[128:143], v[196:199], v[208:211], v[128:143]
  s_add_u32 m0, s45, 106496
  s_nop 0
  buffer_load_dwordx4 v229, s[24:27], s43 offen lds
  ds_read_b64_tr_b16 a[44:45], v255 offset:10240
  ds_read_b64_tr_b16 a[46:47], v255 offset:11264
  v_mfma_f32_32x32x16_bf16 v[144:159], v[196:199], v[212:215], v[144:159]
  s_add_u32 s44, s44, 128
  s_and_b32 s44, s44, 1023
  s_add_u32 s59, s47, s44
  s_add_u32 m0, s46, 32768
  s_nop 0
  buffer_load_dwordx4 v230, s[4:7], s59 offen lds
  s_waitcnt lgkmcnt(0)
  v_mfma_f32_32x32x16_bf16 v[0:15], v[200:203], v[160:163], v[0:15]
  ds_read_b128 v[208:211], v222 offset:0
  s_add_u32 m0, s46, 33792
  ds_read_b128 v[212:215], v222 offset:4096
  buffer_load_dwordx4 v231, s[4:7], s59 offen lds
  v_mfma_f32_32x32x16_bf16 v[16:31], v[204:207], v[160:163], v[16:31]
  ds_read_b64_tr_b16 v[180:181], v216 offset:2048
  s_add_u32 m0, s46, 34816
  ds_read_b64_tr_b16 v[182:183], v216 offset:2560
  buffer_load_dwordx4 v232, s[4:7], s59 offen lds
  v_mfma_f32_32x32x16_bf16 v[32:47], v[200:203], v[164:167], v[32:47]
  ds_read_b64_tr_b16 v[184:185], v217 offset:2048
  s_add_u32 m0, s46, 35840
  ds_read_b64_tr_b16 v[186:187], v217 offset:2560
  buffer_load_dwordx4 v233, s[4:7], s59 offen lds
  v_mfma_f32_32x32x16_bf16 v[48:63], v[204:207], v[164:167], v[48:63]
  ds_read_b64_tr_b16 v[188:189], v218 offset:2048
  s_add_u32 m0, s52, 8192
  ds_read_b64_tr_b16 v[190:191], v218 offset:2560
  buffer_load_dwordx4 v239, s[48:51], s75 offen lds
  v_mfma_f32_32x32x16_bf16 v[64:79], v[168:171], v[200:203], v[64:79]
  ds_read_b64_tr_b16 v[192:193], v219 offset:2048
  s_add_u32 m0, s52, 9216
  ds_read_b64_tr_b16 v[194:195], v219 offset:2560
  buffer_load_dwordx4 v226, s[48:51], s75 offen lds
  v_mfma_f32_32x32x16_bf16 v[80:95], v[168:171], v[204:207], v[80:95]
  ds_read_b64_tr_b16 v[196:197], v220 offset:1024
  ds_read_b64_tr_b16 v[198:199], v220 offset:1280
  s_add_u32 s75, s75, 16384
  s_cmp_eq_u32 s75, 458752
  s_cselect_b32 s75, 0, s75
  v_mfma_f32_32x32x16_bf16 v[96:111], v[172:175], v[200:203], v[96:111]
  s_waitcnt vmcnt(22)
  ds_read_b64_tr_b16 a[48:49], v254 offset:0
  ds_read_b64_tr_b16 a[50:51], v254 offset:1024
  ds_read_b64_tr_b16 a[52:53], v255 offset:0
  ds_read_b64_tr_b16 a[54:55], v255 offset:1024
  v_mfma_f32_32x32x16_bf16 v[112:127], v[172:175], v[204:207], v[112:127]
  s_add_u32 m0, s52, 10240
  s_nop 0
  buffer_load_dwordx4 v239, s[48:51], s75 offen lds
  v_mfma_f32_32x32x16_bf16 v[128:143], v[176:179], v[200:203], v[128:143]
  s_add_u32 m0, s52, 11264
  s_nop 0
  buffer_load_dwordx4 v226, s[48:51], s75 offen lds
  v_mfma_f32_32x32x16_bf16 v[144:159], v[176:179], v[204:207], v[144:159]
  s_add_u32 s75, s75, 16384
  s_cmp_eq_u32 s75, 458752
  s_cselect_b32 s75, 0, s75
  s_waitcnt lgkmcnt(0)
  v_mfma_f32_32x32x16_bf16 v[0:15], v[208:211], v[180:183], v[0:15]
  s_waitcnt vmcnt(17)
  s_barrier
  s_waitcnt vmcnt(22)
  ds_read_b64_tr_b16 a[56:57], v254 offset:2048
  ds_read_b64_tr_b16 a[58:59], v254 offset:3072
  v_mfma_f32_32x32x16_bf16 v[16:31], v[212:215], v[180:183], v[16:31]
  ds_read_b128 v[200:203], v223 offset:0
  ds_read_b128 v[204:207], v223 offset:4096
  s_add_u32 s39, s39, 32
  s_and_b32 s39, s39, 511
  v_mfma_f32_32x32x16_bf16 v[32:47], v[208:211], v[184:187], v[32:47]
  ds_read_b64_tr_b16 v[160:161], v216 offset:20480
  ds_read_b64_tr_b16 v[162:163], v216 offset:20992
  s_add_u32 s40, s40, 32
  s_and_b32 s40, s40, 511
  v_mfma_f32_32x32x16_bf16 v[48:63], v[212:215], v[184:187], v[48:63]
  ds_read_b64_tr_b16 v[164:165], v217 offset:20480
  ds_read_b64_tr_b16 v[166:167], v217 offset:20992
  s_mul_i32 s41, s39, 3072
  s_mul_i32 s42, s39, 3584
  s_mul_i32 s43, s40, 3584
  v_mfma_f32_32x32x16_bf16 v[64:79], v[188:191], v[208:211], v[64:79]
  ds_read_b64_tr_b16 v[168:169], v218 offset:20480
  s_add_u32 m0, s45, 49152
  ds_read_b64_tr_b16 v[170:171], v218 offset:20992
  buffer_load_dwordx4 v225, s[8:11], s41 offen lds
  v_mfma_f32_32x32x16_bf16 v[80:95], v[188:191], v[212:215], v[80:95]
  ds_read_b64_tr_b16 v[172:173], v219 offset:20480
  s_add_u32 m0, s45, 53248
  ds_read_b64_tr_b16 v[174:175], v219 offset:20992
  buffer_load_dwordx4 v225, s[12:15], s41 offen lds
  v_mfma_f32_32x32x16_bf16 v[96:111], v[192:195], v[208:211], v[96:111]
  ds_read_b64_tr_b16 v[176:177], v220 offset:20480
  s_add_u32 m0, s45, 57344
  ds_read_b64_tr_b16 v[178:179], v220 offset:20736
  buffer_load_dwordx4 v227, s[16:19], s42 offen lds
  v_mfma_f32_32x32x16_bf16 v[112:127], v[192:195], v[212:215], v[112:127]
  s_add_u32 m0, s45, 61440
  s_nop 0
  buffer_load_dwordx4 v228, s[20:23], s42 offen lds
  ds_read_b64_tr_b16 a[60:61], v255 offset:2048
  ds_read_b64_tr_b16 a[62:63], v255 offset:3072
  v_mfma_f32_32x32x16_bf16 v[128:143], v[196:199], v[208:211], v[128:143]
  s_add_u32 m0, s45, 65536
  s_nop 0
  buffer_load_dwordx4 v229, s[24:27], s43 offen lds
  s_add_u32 m0, s52, 0
  s_nop 0
  buffer_load_dwordx4 v239, s[48:51], s75 offen lds
  v_mfma_f32_32x32x16_bf16 v[144:159], v[196:199], v[212:215], v[144:159]
  s_add_u32 m0, s52, 1024
  s_nop 0
  buffer_load_dwordx4 v226, s[48:51], s75 offen lds
  s_waitcnt lgkmcnt(0)
  v_mfma_f32_32x32x16_bf16 v[0:15], v[200:203], v[160:163], v[0:15]
  ds_read_b128 v[208:211], v224 offset:0
  ds_read_b128 v[212:215], v224 offset:4096
  s_add_u32 s75, s75, 16384
  s_cmp_eq_u32 s75, 458752
  s_cselect_b32 s75, 0, s75
  v_mfma_f32_32x32x16_bf16 v[16:31], v[204:207], v[160:163], v[16:31]
  ds_read_b64_tr_b16 v[180:181], v216 offset:22528
  ds_read_b64_tr_b16 v[182:183], v216 offset:23040
  s_waitcnt vmcnt(22)
  ds_read_b64_tr_b16 a[64:65], v254 offset:4096
  ds_read_b64_tr_b16 a[66:67], v254 offset:5120
  v_mfma_f32_32x32x16_bf16 v[32:47], v[200:203], v[164:167], v[32:47]
  ds_read_b64_tr_b16 v[184:185], v217 offset:22528
  ds_read_b64_tr_b16 v[186:187], v217 offset:23040
  ds_read_b64_tr_b16 a[68:69], v255 offset:4096
  ds_read_b64_tr_b16 a[70:71], v255 offset:5120
  v_mfma_f32_32x32x16_bf16 v[48:63], v[204:207], v[164:167], v[48:63]
  ds_read_b64_tr_b16 v[188:189], v218 offset:22528
  s_add_u32 m0, s52, 2048
  ds_read_b64_tr_b16 v[190:191], v218 offset:23040
  buffer_load_dwordx4 v239, s[48:51], s75 offen lds
  v_mfma_f32_32x32x16_bf16 v[64:79], v[168:171], v[200:203], v[64:79]
  ds_read_b64_tr_b16 v[192:193], v219 offset:22528
  s_add_u32 m0, s52, 3072
  ds_read_b64_tr_b16 v[194:195], v219 offset:23040
  buffer_load_dwordx4 v226, s[48:51], s75 offen lds
  v_mfma_f32_32x32x16_bf16 v[80:95], v[168:171], v[204:207], v[80:95]
  ds_read_b64_tr_b16 v[196:197], v220 offset:21504
  ds_read_b64_tr_b16 v[198:199], v220 offset:21760
  s_add_u32 s75, s75, 16384
  s_cmp_eq_u32 s75, 458752
  s_cselect_b32 s75, 0, s75
  v_mfma_f32_32x32x16_bf16 v[96:111], v[172:175], v[200:203], v[96:111]
  v_mfma_f32_32x32x16_bf16 v[112:127], v[172:175], v[204:207], v[112:127]
  v_mfma_f32_32x32x16_bf16 v[128:143], v[176:179], v[200:203], v[128:143]
  v_mfma_f32_32x32x16_bf16 v[144:159], v[176:179], v[204:207], v[144:159]
  s_waitcnt lgkmcnt(0)
  v_mfma_f32_32x32x16_bf16 v[0:15], v[208:211], v[180:183], v[0:15]
  s_waitcnt vmcnt(17)
  s_barrier
  s_waitcnt vmcnt(22)
  ds_read_b64_tr_b16 a[72:73], v254 offset:6144
  ds_read_b64_tr_b16 a[74:75], v254 offset:7168
  v_mfma_f32_32x32x16_bf16 v[16:31], v[212:215], v[180:183], v[16:31]
  ds_read_b128 v[200:203], v221 offset:16384
  ds_read_b128 v[204:207], v221 offset:20480
  s_add_u32 s39, s39, 32
  s_and_b32 s39, s39, 511
  v_mfma_f32_32x32x16_bf16 v[32:47], v[208:211], v[184:187], v[32:47]
  ds_read_b64_tr_b16 v[160:161], v216 offset:40960
  ds_read_b64_tr_b16 v[162:163], v216 offset:41472
  s_add_u32 s40, s40, 32
  s_and_b32 s40, s40, 511
  v_mfma_f32_32x32x16_bf16 v[48:63], v[212:215], v[184:187], v[48:63]
  ds_read_b64_tr_b16 v[164:165], v217 offset:40960
  ds_read_b64_tr_b16 v[166:167], v217 offset:41472
  s_mul_i32 s41, s39, 3072
  s_mul_i32 s42, s39, 3584
  s_mul_i32 s43, s40, 3584
  v_mfma_f32_32x32x16_bf16 v[64:79], v[188:191], v[208:211], v[64:79]
  ds_read_b64_tr_b16 v[168:169], v218 offset:40960
  s_add_u32 m0, s45, 69632
  ds_read_b64_tr_b16 v[170:171], v218 offset:41472
  buffer_load_dwordx4 v225, s[8:11], s41 offen lds
  v_mfma_f32_32x32x16_bf16 v[80:95], v[188:191], v[212:215], v[80:95]
  ds_read_b64_tr_b16 v[172:173], v219 offset:40960
  s_add_u32 m0, s45, 73728
  ds_read_b64_tr_b16 v[174:175], v219 offset:41472
  buffer_load_dwordx4 v225, s[12:15], s41 offen lds
  v_mfma_f32_32x32x16_bf16 v[96:111], v[192:195], v[208:211], v[96:111]
  ds_read_b64_tr_b16 v[176:177], v220 offset:40960
  s_add_u32 m0, s45, 77824
  ds_read_b64_tr_b16 v[178:179], v220 offset:41216
  buffer_load_dwordx4 v227, s[16:19], s42 offen lds
  v_mfma_f32_32x32x16_bf16 v[112:127], v[192:195], v[212:215], v[112:127]
  s_add_u32 m0, s45, 81920
  s_nop 0
  buffer_load_dwordx4 v228, s[20:23], s42 offen lds
  ds_read_b64_tr_b16 a[76:77], v255 offset:6144
  ds_read_b64_tr_b16 a[78:79], v255 offset:7168
  v_mfma_f32_32x32x16_bf16 v[128:143], v[196:199], v[208:211], v[128:143]
  s_add_u32 m0, s45, 86016
  s_nop 0
  buffer_load_dwordx4 v229, s[24:27], s43 offen lds
  s_add_u32 m0, s52, 4096
  s_nop 0
  buffer_load_dwordx4 v239, s[48:51], s75 offen lds
  v_mfma_f32_32x32x16_bf16 v[144:159], v[196:199], v[212:215], v[144:159]
  s_add_u32 s44, s44, 128
  s_and_b32 s44, s44, 1023
  s_add_u32 s59, s47, s44
  s_add_u32 m0, s46, 0
  s_nop 0
  buffer_load_dwordx4 v230, s[4:7], s59 offen lds
  s_waitcnt lgkmcnt(0)
  v_mfma_f32_32x32x16_bf16 v[0:15], v[200:203], v[160:163], v[0:15]
  ds_read_b128 v[208:211], v222 offset:16384
  s_add_u32 m0, s46, 1024
  ds_read_b128 v[212:215], v222 offset:20480
  buffer_load_dwordx4 v231, s[4:7], s59 offen lds
  v_mfma_f32_32x32x16_bf16 v[16:31], v[204:207], v[160:163], v[16:31]
  ds_read_b64_tr_b16 v[180:181], v216 offset:43008
  s_add_u32 m0, s46, 2048
  ds_read_b64_tr_b16 v[182:183], v216 offset:43520
  buffer_load_dwordx4 v232, s[4:7], s59 offen lds
  v_mfma_f32_32x32x16_bf16 v[32:47], v[200:203], v[164:167], v[32:47]
  ds_read_b64_tr_b16 v[184:185], v217 offset:43008
  s_add_u32 m0, s46, 3072
  ds_read_b64_tr_b16 v[186:187], v217 offset:43520
  buffer_load_dwordx4 v233, s[4:7], s59 offen lds
  v_mfma_f32_32x32x16_bf16 v[48:63], v[204:207], v[164:167], v[48:63]
  ds_read_b64_tr_b16 v[188:189], v218 offset:43008
  s_add_u32 m0, s52, 5120
  ds_read_b64_tr_b16 v[190:191], v218 offset:43520
  buffer_load_dwordx4 v226, s[48:51], s75 offen lds
  v_mfma_f32_32x32x16_bf16 v[64:79], v[168:171], v[200:203], v[64:79]
  ds_read_b64_tr_b16 v[192:193], v219 offset:43008
  ds_read_b64_tr_b16 v[194:195], v219 offset:43520
  s_add_u32 s75, s75, 16384
  s_cmp_eq_u32 s75, 458752
  s_cselect_b32 s75, 0, s75
  v_mfma_f32_32x32x16_bf16 v[80:95], v[168:171], v[204:207], v[80:95]
  ds_read_b64_tr_b16 v[196:197], v220 offset:41984
  ds_read_b64_tr_b16 v[198:199], v220 offset:42240
  s_waitcnt vmcnt(22)
  ds_read_b64_tr_b16 a[80:81], v254 offset:8192
  ds_read_b64_tr_b16 a[82:83], v254 offset:9216
  v_mfma_f32_32x32x16_bf16 v[96:111], v[172:175], v[200:203], v[96:111]
  ds_read_b64_tr_b16 a[84:85], v255 offset:8192
  s_add_u32 m0, s52, 6144
  ds_read_b64_tr_b16 a[86:87], v255 offset:9216
  buffer_load_dwordx4 v239, s[48:51], s75 offen lds
  v_mfma_f32_32x32x16_bf16 v[112:127], v[172:175], v[204:207], v[112:127]
  s_add_u32 m0, s52, 7168
  s_nop 0
  buffer_load_dwordx4 v226, s[48:51], s75 offen lds
  v_mfma_f32_32x32x16_bf16 v[128:143], v[176:179], v[200:203], v[128:143]
  s_add_u32 s75, s75, 16384
  s_cmp_eq_u32 s75, 458752
  s_cselect_b32 s75, 0, s75
  v_mfma_f32_32x32x16_bf16 v[144:159], v[176:179], v[204:207], v[144:159]
  s_waitcnt lgkmcnt(0)
  v_mfma_f32_32x32x16_bf16 v[0:15], v[208:211], v[180:183], v[0:15]
  s_waitcnt vmcnt(17)
  s_barrier
  s_waitcnt vmcnt(22)
  ds_read_b64_tr_b16 a[88:89], v254 offset:10240
  ds_read_b64_tr_b16 a[90:91], v254 offset:11264
  v_mfma_f32_32x32x16_bf16 v[16:31], v[212:215], v[180:183], v[16:31]
  ds_read_b128 v[200:203], v223 offset:16384
  ds_read_b128 v[204:207], v223 offset:20480
  s_add_u32 s39, s39, 32
  s_and_b32 s39, s39, 511
  v_mfma_f32_32x32x16_bf16 v[32:47], v[208:211], v[184:187], v[32:47]
  ds_read_b64_tr_b16 v[160:161], v216 offset:0
  ds_read_b64_tr_b16 v[162:163], v216 offset:512
  s_add_u32 s40, s40, 32
  s_and_b32 s40, s40, 511
  v_mfma_f32_32x32x16_bf16 v[48:63], v[212:215], v[184:187], v[48:63]
  ds_read_b64_tr_b16 v[164:165], v217 offset:0
  ds_read_b64_tr_b16 v[166:167], v217 offset:512
  s_mul_i32 s41, s39, 3072
  s_mul_i32 s42, s39, 3584
  s_mul_i32 s43, s40, 3584
  v_mfma_f32_32x32x16_bf16 v[64:79], v[188:191], v[208:211], v[64:79]
  ds_read_b64_tr_b16 v[168:169], v218 offset:0
  s_add_u32 m0, s45, 90112
  ds_read_b64_tr_b16 v[170:171], v218 offset:512
  buffer_load_dwordx4 v225, s[8:11], s41 offen lds
  v_mfma_f32_32x32x16_bf16 v[80:95], v[188:191], v[212:215], v[80:95]
  ds_read_b64_tr_b16 v[172:173], v219 offset:0
  s_add_u32 m0, s45, 94208
  ds_read_b64_tr_b16 v[174:175], v219 offset:512
  buffer_load_dwordx4 v225, s[12:15], s41 offen lds
  v_mfma_f32_32x32x16_bf16 v[96:111], v[192:195], v[208:211], v[96:111]
  ds_read_b64_tr_b16 v[176:177], v220 offset:0
  s_add_u32 m0, s45, 98304
  ds_read_b64_tr_b16 v[178:179], v220 offset:256
  buffer_load_dwordx4 v227, s[16:19], s42 offen lds
  v_mfma_f32_32x32x16_bf16 v[112:127], v[192:195], v[212:215], v[112:127]
  s_add_u32 m0, s45, 102400
  s_nop 0
  buffer_load_dwordx4 v228, s[20:23], s42 offen lds
  ds_read_b64_tr_b16 a[92:93], v255 offset:10240
  ds_read_b64_tr_b16 a[94:95], v255 offset:11264
  v_mfma_f32_32x32x16_bf16 v[128:143], v[196:199], v[208:211], v[128:143]
  s_add_u32 m0, s45, 106496
  s_nop 0
  buffer_load_dwordx4 v229, s[24:27], s43 offen lds
  s_add_u32 m0, s52, 8192
  s_nop 0
  buffer_load_dwordx4 v239, s[48:51], s75 offen lds
  v_mfma_f32_32x32x16_bf16 v[144:159], v[196:199], v[212:215], v[144:159]
  s_add_u32 m0, s52, 9216
  s_nop 0
  buffer_load_dwordx4 v226, s[48:51], s75 offen lds
  s_waitcnt lgkmcnt(0)
  v_mfma_f32_32x32x16_bf16 v[0:15], v[200:203], v[160:163], v[0:15]
  ds_read_b128 v[208:211], v224 offset:16384
  ds_read_b128 v[212:215], v224 offset:20480
  s_add_u32 s75, s75, 16384
  s_cmp_eq_u32 s75, 458752
  s_cselect_b32 s75, 0, s75
  v_mfma_f32_32x32x16_bf16 v[16:31], v[204:207], v[160:163], v[16:31]
  ds_read_b64_tr_b16 v[180:181], v216 offset:2048
  ds_read_b64_tr_b16 v[182:183], v216 offset:2560
  s_waitcnt vmcnt(22)
  ds_read_b64_tr_b16 a[96:97], v254 offset:0
  ds_read_b64_tr_b16 a[98:99], v254 offset:1024
  v_mfma_f32_32x32x16_bf16 v[32:47], v[200:203], v[164:167], v[32:47]
  ds_read_b64_tr_b16 v[184:185], v217 offset:2048
  ds_read_b64_tr_b16 v[186:187], v217 offset:2560
  ds_read_b64_tr_b16 a[100:101], v255 offset:0
  ds_read_b64_tr_b16 a[102:103], v255 offset:1024
  v_mfma_f32_32x32x16_bf16 v[48:63], v[204:207], v[164:167], v[48:63]
  ds_read_b64_tr_b16 v[188:189], v218 offset:2048
  s_add_u32 m0, s52, 10240
  ds_read_b64_tr_b16 v[190:191], v218 offset:2560
  buffer_load_dwordx4 v239, s[48:51], s75 offen lds
  v_mfma_f32_32x32x16_bf16 v[64:79], v[168:171], v[200:203], v[64:79]
  ds_read_b64_tr_b16 v[192:193], v219 offset:2048
  s_add_u32 m0, s52, 11264
  ds_read_b64_tr_b16 v[194:195], v219 offset:2560
  buffer_load_dwordx4 v226, s[48:51], s75 offen lds
  v_mfma_f32_32x32x16_bf16 v[80:95], v[168:171], v[204:207], v[80:95]
  ds_read_b64_tr_b16 v[196:197], v220 offset:1024
  ds_read_b64_tr_b16 v[198:199], v220 offset:1280
  s_add_u32 s75, s75, 16384
  s_cmp_eq_u32 s75, 458752
  s_cselect_b32 s75, 0, s75
  v_mfma_f32_32x32x16_bf16 v[96:111], v[172:175], v[200:203], v[96:111]
  v_mfma_f32_32x32x16_bf16 v[112:127], v[172:175], v[204:207], v[112:127]
  v_mfma_f32_32x32x16_bf16 v[128:143], v[176:179], v[200:203], v[128:143]
  v_mfma_f32_32x32x16_bf16 v[144:159], v[176:179], v[204:207], v[144:159]
  s_cmp_eq_u32 s34, 0
  s_cbranch_scc0 K12B_w0_cntld
  s_lshl_b32 s58, s37, 7
  s_add_u32 s58, s58, 100352
  v_mov_b32 v247, s58
  s_lshl_b32 s58, s67, 7
  s_add_u32 s58, s58, 102400
  v_mov_b32 v248, s58
  s_mov_b64 s[60:61], exec
  s_mov_b64 exec, 1
  global_load_dword v245, v247, s[32:33] sc1
  global_load_dword v246, v248, s[32:33] sc1
  s_mov_b64 exec, s[60:61]
K12B_w0_cntld:
  s_waitcnt lgkmcnt(0)
  v_mfma_f32_32x32x16_bf16 v[0:15], v[208:211], v[180:183], v[0:15]
  s_waitcnt vmcnt(17)
  s_barrier
  s_waitcnt vmcnt(22)
  ds_read_b64_tr_b16 a[104:105], v254 offset:2048
  ds_read_b64_tr_b16 a[106:107], v254 offset:3072
  v_mfma_f32_32x32x16_bf16 v[16:31], v[212:215], v[180:183], v[16:31]
  ds_read_b128 v[200:203], v221 offset:32768
  ds_read_b128 v[204:207], v221 offset:36864
  s_add_u32 s39, s39, 32
  s_and_b32 s39, s39, 511
  v_mfma_f32_32x32x16_bf16 v[32:47], v[208:211], v[184:187], v[32:47]
  ds_read_b64_tr_b16 v[160:161], v216 offset:20480
  ds_read_b64_tr_b16 v[162:163], v216 offset:20992
  s_add_u32 s40, s40, 32
  s_and_b32 s40, s40, 511
  v_mfma_f32_32x32x16_bf16 v[48:63], v[212:215], v[184:187], v[48:63]
  ds_read_b64_tr_b16 v[164:165], v217 offset:20480
  ds_read_b64_tr_b16 v[166:167], v217 offset:20992
  s_mul_i32 s41, s39, 3072
  s_mul_i32 s42, s39, 3584
  s_mul_i32 s43, s40, 3584
  v_mfma_f32_32x32x16_bf16 v[64:79], v[188:191], v[208:211], v[64:79]
  ds_read_b64_tr_b16 v[168:169], v218 offset:20480
  s_add_u32 m0, s45, 49152
  ds_read_b64_tr_b16 v[170:171], v218 offset:20992
  buffer_load_dwordx4 v225, s[8:11], s41 offen lds
  v_mfma_f32_32x32x16_bf16 v[80:95], v[188:191], v[212:215], v[80:95]
  ds_read_b64_tr_b16 v[172:173], v219 offset:20480
  s_add_u32 m0, s45, 53248
  ds_read_b64_tr_b16 v[174:175], v219 offset:20992
  buffer_load_dwordx4 v225, s[12:15], s41 offen lds
  v_mfma_f32_32x32x16_bf16 v[96:111], v[192:195], v[208:211], v[96:111]
  ds_read_b64_tr_b16 v[176:177], v220 offset:20480
  s_add_u32 m0, s45, 57344
  ds_read_b64_tr_b16 v[178:179], v220 offset:20736
  buffer_load_dwordx4 v227, s[16:19], s42 offen lds
  v_mfma_f32_32x32x16_bf16 v[112:127], v[192:195], v[212:215], v[112:127]
  s_add_u32 m0, s45, 61440
  s_nop 0
  buffer_load_dwordx4 v228, s[20:23], s42 offen lds
  ds_read_b64_tr_b16 a[108:109], v255 offset:2048
  ds_read_b64_tr_b16 a[110:111], v255 offset:3072
  v_mfma_f32_32x32x16_bf16 v[128:143], v[196:199], v[208:211], v[128:143]
  s_add_u32 m0, s45, 65536
  s_nop 0
  buffer_load_dwordx4 v229, s[24:27], s43 offen lds
  s_add_u32 m0, s52, 0
  s_nop 0
  buffer_load_dwordx4 v239, s[48:51], s75 offen lds
  v_mfma_f32_32x32x16_bf16 v[144:159], v[196:199], v[212:215], v[144:159]
  s_add_u32 s44, s44, 128
  s_and_b32 s44, s44, 1023
  s_add_u32 s59, s47, s44
  s_add_u32 m0, s46, 16384
  s_nop 0
  buffer_load_dwordx4 v230, s[4:7], s59 offen lds
  s_waitcnt lgkmcnt(0)
  v_mfma_f32_32x32x16_bf16 v[0:15], v[200:203], v[160:163], v[0:15]
  ds_read_b128 v[208:211], v222 offset:32768
  s_add_u32 m0, s46, 17408
  ds_read_b128 v[212:215], v222 offset:36864
  buffer_load_dwordx4 v231, s[4:7], s59 offen lds
  v_mfma_f32_32x32x16_bf16 v[16:31], v[204:207], v[160:163], v[16:31]
  ds_read_b64_tr_b16 v[180:181], v216 offset:22528
  s_add_u32 m0, s46, 18432
  ds_read_b64_tr_b16 v[182:183], v216 offset:23040
  buffer_load_dwordx4 v232, s[4:7], s59 offen lds
  v_mfma_f32_32x32x16_bf16 v[32:47], v[200:203], v[164:167], v[32:47]
  ds_read_b64_tr_b16 v[184:185], v217 offset:22528
  s_add_u32 m0, s46, 19456
  ds_read_b64_tr_b16 v[186:187], v217 offset:23040
  buffer_load_dwordx4 v233, s[4:7], s59 offen lds
  v_mfma_f32_32x32x16_bf16 v[48:63], v[204:207], v[164:167], v[48:63]
  ds_read_b64_tr_b16 v[188:189], v218 offset:22528
  s_add_u32 m0, s52, 1024
  ds_read_b64_tr_b16 v[190:191], v218 offset:23040
  buffer_load_dwordx4 v226, s[48:51], s75 offen lds
  v_mfma_f32_32x32x16_bf16 v[64:79], v[168:171], v[200:203], v[64:79]
  ds_read_b64_tr_b16 v[192:193], v219 offset:22528
  ds_read_b64_tr_b16 v[194:195], v219 offset:23040
  s_add_u32 s75, s75, 16384
  s_cmp_eq_u32 s75, 458752
  s_cselect_b32 s75, 0, s75
  v_mfma_f32_32x32x16_bf16 v[80:95], v[168:171], v[204:207], v[80:95]
  ds_read_b64_tr_b16 v[196:197], v220 offset:21504
  ds_read_b64_tr_b16 v[198:199], v220 offset:21760
  s_waitcnt vmcnt(22)
  ds_read_b64_tr_b16 a[112:113], v254 offset:4096
  ds_read_b64_tr_b16 a[114:115], v254 offset:5120
  v_mfma_f32_32x32x16_bf16 v[96:111], v[172:175], v[200:203], v[96:111]
  ds_read_b64_tr_b16 a[116:117], v255 offset:4096
  s_add_u32 m0, s52, 2048
  ds_read_b64_tr_b16 a[118:119], v255 offset:5120
  buffer_load_dwordx4 v239, s[48:51], s75 offen lds
  v_mfma_f32_32x32x16_bf16 v[112:127], v[172:175], v[204:207], v[112:127]
  s_add_u32 m0, s52, 3072
  s_nop 0
  buffer_load_dwordx4 v226, s[48:51], s75 offen lds
  v_mfma_f32_32x32x16_bf16 v[128:143], v[176:179], v[200:203], v[128:143]
  s_add_u32 s75, s75, 16384
  s_cmp_eq_u32 s75, 458752
  s_cselect_b32 s75, 0, s75
  v_mfma_f32_32x32x16_bf16 v[144:159], v[176:179], v[204:207], v[144:159]
  s_waitcnt lgkmcnt(0)
  v_mfma_f32_32x32x16_bf16 v[0:15], v[208:211], v[180:183], v[0:15]
  s_cmp_eq_u32 s34, 0
  s_cbranch_scc0 K12B_w0_cntchk
  s_waitcnt vmcnt(13)
  v_readfirstlane_b32 s58, v245
  s_nop 0
  s_cmp_ge_u32 s58, 16
  s_cbranch_scc1 K12B_stok
  s_mov_b32 s57, 0
K12B_spin_st:
  global_load_dword v250, v247, s[32:33] sc1
  s_waitcnt vmcnt(0)
  v_readfirstlane_b32 s58, v250
  s_add_u32 s57, s57, 1
  s_cmp_ge_u32 s57, 200000
  s_cbranch_scc1 K12B_spin_st_x
  s_cmp_ge_u32 s58, 16
  s_cbranch_scc1 K12B_spin_st_x
  s_sleep 2
  s_branch K12B_spin_st
K12B_spin_st_x:
K12B_stok:
  v_readfirstlane_b32 s58, v246
  s_nop 0
  s_cmp_ge_u32 s58, 16
  s_cbranch_scc1 K12B_csok
  s_mov_b32 s57, 0
K12B_spin_cs:
  global_load_dword v250, v248, s[32:33] sc1
  s_waitcnt vmcnt(0)
  v_readfirstlane_b32 s58, v250
  s_add_u32 s57, s57, 1
  s_cmp_ge_u32 s57, 200000
  s_cbranch_scc1 K12B_spin_cs_x
  s_cmp_ge_u32 s58, 16
  s_cbranch_scc1 K12B_spin_cs_x
  s_sleep 2
  s_branch K12B_spin_cs
K12B_spin_cs_x:
K12B_csok:
K12B_w0_cntchk:
  s_waitcnt vmcnt(17)
  s_barrier
  v_mfma_f32_32x32x16_bf16 v[16:31], v[212:215], v[180:183], v[16:31]
  ds_read_b128 v[200:203], v223 offset:32768
  ds_read_b128 v[204:207], v223 offset:36864
  s_add_u32 s39, s39, 32
  s_and_b32 s39, s39, 511
  s_waitcnt vmcnt(22)
  v_mfma_f32_32x32x16_bf16 v[32:47], v[208:211], v[184:187], v[32:47]
  ds_read_b64_tr_b16 v[160:161], v216 offset:40960
  ds_read_b64_tr_b16 v[162:163], v216 offset:41472
  s_add_u32 s40, s40, 32
  s_and_b32 s40, s40, 511
  v_mfma_f32_32x32x16_bf16 v[48:63], v[212:215], v[184:187], v[48:63]
  ds_read_b64_tr_b16 v[164:165], v217 offset:40960
  ds_read_b64_tr_b16 v[166:167], v217 offset:41472
  s_mul_i32 s41, s39, 3072
  s_mul_i32 s42, s39, 3584
  s_mul_i32 s43, s40, 3584
  v_mfma_f32_32x32x16_bf16 v[64:79], v[188:191], v[208:211], v[64:79]
  ds_read_b64_tr_b16 v[168:169], v218 offset:40960
  s_add_u32 m0, s45, 69632
  ds_read_b64_tr_b16 v[170:171], v218 offset:41472
  buffer_load_dwordx4 v225, s[8:11], s41 offen lds
  v_mfma_f32_32x32x16_bf16 v[80:95], v[188:191], v[212:215], v[80:95]
  ds_read_b64_tr_b16 v[172:173], v219 offset:40960
  s_add_u32 m0, s45, 73728
  ds_read_b64_tr_b16 v[174:175], v219 offset:41472
  buffer_load_dwordx4 v225, s[12:15], s41 offen lds
  v_mfma_f32_32x32x16_bf16 v[96:111], v[192:195], v[208:211], v[96:111]
  ds_read_b64_tr_b16 v[176:177], v220 offset:40960
  s_add_u32 m0, s45, 77824
  ds_read_b64_tr_b16 v[178:179], v220 offset:41216
  buffer_load_dwordx4 v227, s[16:19], s42 offen lds
  v_mfma_f32_32x32x16_bf16 v[112:127], v[192:195], v[212:215], v[112:127]
  s_add_u32 m0, s45, 81920
  s_nop 0
  buffer_load_dwordx4 v228, s[20:23], s42 offen lds
  ds_read_b64_tr_b16 a[120:121], v254 offset:6144
  ds_read_b64_tr_b16 a[122:123], v254 offset:7168
  v_mfma_f32_32x32x16_bf16 v[128:143], v[196:199], v[208:211], v[128:143]
  s_add_u32 m0, s45, 86016
  s_nop 0
  buffer_load_dwordx4 v229, s[24:27], s43 offen lds
  ds_read_b64_tr_b16 a[124:125], v255 offset:6144
  ds_read_b64_tr_b16 a[126:127], v255 offset:7168
  v_mfma_f32_32x32x16_bf16 v[144:159], v[196:199], v[212:215], v[144:159]
  v_and_b32 v248, 31, v236
  s_lshl_b32 s58, s37, 7
  s_lshl_b32 s57, s35, 6
  s_add_u32 s58, s58, s57
  s_waitcnt lgkmcnt(0)
  v_mfma_f32_32x32x16_bf16 v[0:15], v[200:203], v[160:163], v[0:15]
  ds_read_b128 v[208:211], v224 offset:32768
  ds_read_b128 v[212:215], v224 offset:36864
  v_add_u32 v248, s58, v248
  v_lshlrev_b32 v248, 2, v248
  v_add_u32 v249, 8192, v248
  v_mfma_f32_32x32x16_bf16 v[16:31], v[204:207], v[160:163], v[16:31]
  ds_read_b64_tr_b16 v[180:181], v216 offset:43008
  ds_read_b64_tr_b16 v[182:183], v216 offset:43520
  global_load_dword v240, v248, s[32:33] sc1
  global_load_dword v241, v248, s[32:33] offset:128 sc1
  global_load_dword v234, v249, s[32:33] sc1
  v_mfma_f32_32x32x16_bf16 v[32:47], v[200:203], v[164:167], v[32:47]
  ds_read_b64_tr_b16 v[184:185], v217 offset:43008
  ds_read_b64_tr_b16 v[186:187], v217 offset:43520
  global_load_dword v235, v249, s[32:33] offset:128 sc1
  global_load_dword v242, v252, s[32:33] offset:0 sc1
  global_load_dword v243, v252, s[32:33] offset:2048 sc1
  v_mfma_f32_32x32x16_bf16 v[48:63], v[204:207], v[164:167], v[48:63]
  ds_read_b64_tr_b16 v[188:189], v218 offset:43008
  ds_read_b64_tr_b16 v[190:191], v218 offset:43520
  global_load_dword v244, v251, s[32:33] offset:0 sc1
  global_load_dword v245, v251, s[32:33] offset:64 sc1
  global_load_dword v246, v253, s[32:33] offset:0 sc1
  v_mfma_f32_32x32x16_bf16 v[64:79], v[168:171], v[200:203], v[64:79]
  ds_read_b64_tr_b16 v[192:193], v219 offset:43008
  s_add_u32 m0, s52, 4096
  ds_read_b64_tr_b16 v[194:195], v219 offset:43520
  buffer_load_dwordx4 v239, s[48:51], s75 offen lds
  v_mfma_f32_32x32x16_bf16 v[80:95], v[168:171], v[204:207], v[80:95]
  ds_read_b64_tr_b16 v[196:197], v220 offset:41984
  s_add_u32 m0, s52, 5120
  ds_read_b64_tr_b16 v[198:199], v220 offset:42240
  buffer_load_dwordx4 v226, s[48:51], s75 offen lds
  v_mfma_f32_32x32x16_bf16 v[96:111], v[172:175], v[200:203], v[96:111]
  s_lshl_b32 s58, s37, 7
  v_add_u32 v248, s58, v238
  v_lshlrev_b32 v248, 2, v248
  v_add_u32 v248, 8192, v248
  global_load_dword v247, v248, s[32:33] sc1
  v_mfma_f32_32x32x16_bf16 v[112:127], v[172:175], v[204:207], v[112:127]
  s_add_u32 s75, s75, 16384
  s_cmp_eq_u32 s75, 458752
  s_cselect_b32 s75, 0, s75
  s_waitcnt vmcnt(32)
  v_mfma_f32_32x32x16_bf16 v[128:143], v[176:179], v[200:203], v[128:143]
  ds_read_b64_tr_b16 a[128:129], v254 offset:8192
  ds_read_b64_tr_b16 a[130:131], v254 offset:9216
  ds_read_b64_tr_b16 a[132:133], v255 offset:8192
  ds_read_b64_tr_b16 a[134:135], v255 offset:9216
  v_mfma_f32_32x32x16_bf16 v[144:159], v[176:179], v[204:207], v[144:159]
  s_add_u32 m0, s52, 6144
  s_nop 0
  buffer_load_dwordx4 v239, s[48:51], s75 offen lds
  s_waitcnt lgkmcnt(0)
  v_mfma_f32_32x32x16_bf16 v[0:15], v[208:211], v[180:183], v[0:15]
  s_waitcnt vmcnt(26)
  s_barrier
  s_add_u32 m0, s52, 7168
  s_nop 0
  buffer_load_dwordx4 v226, s[48:51], s75 offen lds
  v_mfma_f32_32x32x16_bf16 v[16:31], v[212:215], v[180:183], v[16:31]
  ds_read_b128 v[200:203], v221 offset:0
  ds_read_b128 v[204:207], v221 offset:4096
  s_add_u32 s39, s39, 32
  s_and_b32 s39, s39, 511
  v_mfma_f32_32x32x16_bf16 v[32:47], v[208:211], v[184:187], v[32:47]
  ds_read_b64_tr_b16 v[160:161], v216 offset:0
  ds_read_b64_tr_b16 v[162:163], v216 offset:512
  s_add_u32 s40, s40, 32
  s_and_b32 s40, s40, 511
  v_mfma_f32_32x32x16_bf16 v[48:63], v[212:215], v[184:187], v[48:63]
  ds_read_b64_tr_b16 v[164:165], v217 offset:0
  ds_read_b64_tr_b16 v[166:167], v217 offset:512
  s_mul_i32 s41, s39, 3072
  s_mul_i32 s42, s39, 3584
  s_mul_i32 s43, s40, 3584
  v_mfma_f32_32x32x16_bf16 v[64:79], v[188:191], v[208:211], v[64:79]
  ds_read_b64_tr_b16 v[168:169], v218 offset:0
  s_add_u32 m0, s45, 90112
  ds_read_b64_tr_b16 v[170:171], v218 offset:512
  buffer_load_dwordx4 v225, s[8:11], s41 offen lds
  v_mfma_f32_32x32x16_bf16 v[80:95], v[188:191], v[212:215], v[80:95]
  ds_read_b64_tr_b16 v[172:173], v219 offset:0
  s_add_u32 m0, s45, 94208
  ds_read_b64_tr_b16 v[174:175], v219 offset:512
  buffer_load_dwordx4 v225, s[12:15], s41 offen lds
  v_mfma_f32_32x32x16_bf16 v[96:111], v[192:195], v[208:211], v[96:111]
  ds_read_b64_tr_b16 v[176:177], v220 offset:0
  s_add_u32 m0, s45, 98304
  ds_read_b64_tr_b16 v[178:179], v220 offset:256
  buffer_load_dwordx4 v227, s[16:19], s42 offen lds
  v_mfma_f32_32x32x16_bf16 v[112:127], v[192:195], v[212:215], v[112:127]
  s_add_u32 m0, s45, 102400
  s_nop 0
  buffer_load_dwordx4 v228, s[20:23], s42 offen lds
  v_mfma_f32_32x32x16_bf16 v[128:143], v[196:199], v[208:211], v[128:143]
  s_add_u32 m0, s45, 106496
  s_nop 0
  buffer_load_dwordx4 v229, s[24:27], s43 offen lds
  v_mfma_f32_32x32x16_bf16 v[144:159], v[196:199], v[212:215], v[144:159]
  s_add_u32 s75, s75, 16384
  s_cmp_eq_u32 s75, 458752
  s_cselect_b32 s75, 0, s75
  s_waitcnt vmcnt(37)
  s_waitcnt lgkmcnt(0)
  v_mfma_f32_32x32x16_bf16 v[0:15], v[200:203], v[160:163], v[0:15]
  ds_read_b128 v[208:211], v222 offset:0
  ds_read_b128 v[212:215], v222 offset:4096
  ds_read_b64_tr_b16 a[136:137], v254 offset:10240
  ds_read_b64_tr_b16 a[138:139], v254 offset:11264
  v_mfma_f32_32x32x16_bf16 v[16:31], v[204:207], v[160:163], v[16:31]
  ds_read_b64_tr_b16 v[180:181], v216 offset:2048
  ds_read_b64_tr_b16 v[182:183], v216 offset:2560
  ds_read_b64_tr_b16 a[140:141], v255 offset:10240
  ds_read_b64_tr_b16 a[142:143], v255 offset:11264
  v_mfma_f32_32x32x16_bf16 v[32:47], v[200:203], v[164:167], v[32:47]
  ds_read_b64_tr_b16 v[184:185], v217 offset:2048
  s_add_u32 m0, s52, 8192
  ds_read_b64_tr_b16 v[186:187], v217 offset:2560
  buffer_load_dwordx4 v239, s[48:51], s75 offen lds
  v_mfma_f32_32x32x16_bf16 v[48:63], v[204:207], v[164:167], v[48:63]
  ds_read_b64_tr_b16 v[188:189], v218 offset:2048
  s_add_u32 m0, s52, 9216
  ds_read_b64_tr_b16 v[190:191], v218 offset:2560
  buffer_load_dwordx4 v226, s[48:51], s75 offen lds
  v_mfma_f32_32x32x16_bf16 v[64:79], v[168:171], v[200:203], v[64:79]
  ds_read_b64_tr_b16 v[192:193], v219 offset:2048
  ds_read_b64_tr_b16 v[194:195], v219 offset:2560
  s_add_u32 s75, s75, 16384
  s_cmp_eq_u32 s75, 458752
  s_cselect_b32 s75, 0, s75
  v_mfma_f32_32x32x16_bf16 v[80:95], v[168:171], v[204:207], v[80:95]
  ds_read_b64_tr_b16 v[196:197], v220 offset:1024
  ds_read_b64_tr_b16 v[198:199], v220 offset:1280
  s_waitcnt vmcnt(28)
  ds_read_b64_tr_b16 a[144:145], v254 offset:0
  ds_read_b64_tr_b16 a[146:147], v254 offset:1024
  v_mfma_f32_32x32x16_bf16 v[96:111], v[172:175], v[200:203], v[96:111]
  ds_read_b64_tr_b16 a[148:149], v255 offset:0
  ds_read_b64_tr_b16 a[150:151], v255 offset:1024
  v_mfma_f32_32x32x16_bf16 v[112:127], v[172:175], v[204:207], v[112:127]
  v_mfma_f32_32x32x16_bf16 v[128:143], v[176:179], v[200:203], v[128:143]
  v_mfma_f32_32x32x16_bf16 v[144:159], v[176:179], v[204:207], v[144:159]
  s_waitcnt lgkmcnt(0)
  v_mfma_f32_32x32x16_bf16 v[0:15], v[208:211], v[180:183], v[0:15]
  s_waitcnt vmcnt(21)
  s_barrier
  s_waitcnt vmcnt(9)
  v_cmp_gt_u32 vcc, 32, v236
  s_nop 1
  v_mfma_f32_32x32x16_bf16 v[16:31], v[212:215], v[180:183], v[16:31]
  ds_read_b128 v[200:203], v223 offset:0
  ds_read_b128 v[204:207], v223 offset:4096
  v_cndmask_b32 v248, 0, v240, vcc
  v_cvt_pk_bf16_f32 v250, v248, v248
  v_and_b32 v249, 0xffff0000, v250
  v_mfma_f32_32x32x16_bf16 v[32:47], v[208:211], v[184:187], v[32:47]
  ds_read_b64_tr_b16 v[160:161], v216 offset:20480
  ds_read_b64_tr_b16 v[162:163], v216 offset:20992
  v_sub_f32 v249, v248, v249
  v_cvt_pk_bf16_f32 v251, v249, 0
  v_accvgpr_write_b32 a228, v250
  v_mfma_f32_32x32x16_bf16 v[48:63], v[212:215], v[184:187], v[48:63]
  ds_read_b64_tr_b16 v[164:165], v217 offset:20480
  ds_read_b64_tr_b16 v[166:167], v217 offset:20992
  v_accvgpr_write_b32 a229, v251
  v_accvgpr_write_b32 a230, 0
  v_accvgpr_write_b32 a231, 0
  v_mfma_f32_32x32x16_bf16 v[64:79], v[188:191], v[208:211], v[64:79]
  ds_read_b64_tr_b16 v[168:169], v218 offset:20480
  ds_read_b64_tr_b16 v[170:171], v218 offset:20992
  v_cndmask_b32 v248, 0, v241, vcc
  v_cvt_pk_bf16_f32 v250, v248, v248
  v_and_b32 v249, 0xffff0000, v250
  v_mfma_f32_32x32x16_bf16 v[80:95], v[188:191], v[212:215], v[80:95]
  ds_read_b64_tr_b16 v[172:173], v219 offset:20480
  ds_read_b64_tr_b16 v[174:175], v219 offset:20992
  v_sub_f32 v249, v248, v249
  v_cvt_pk_bf16_f32 v251, v249, 0
  v_accvgpr_write_b32 a232, v250
  v_mfma_f32_32x32x16_bf16 v[96:111], v[192:195], v[208:211], v[96:111]
  ds_read_b64_tr_b16 v[176:177], v220 offset:20480
  ds_read_b64_tr_b16 v[178:179], v220 offset:20736
  v_accvgpr_write_b32 a233, v251
  v_accvgpr_write_b32 a234, 0
  v_accvgpr_write_b32 a235, 0
  v_mfma_f32_32x32x16_bf16 v[112:127], v[192:195], v[212:215], v[112:127]
  v_cndmask_b32 v248, 0, v242, vcc
  v_sub_f32 v248, 0, v248
  v_cvt_pk_bf16_f32 v251, v248, 0
  v_lshlrev_b32 v249, 16, v251
  v_sub_f32 v249, v248, v249
  v_mfma_f32_32x32x16_bf16 v[128:143], v[196:199], v[208:211], v[128:143]
  v_cvt_pk_bf16_f32 v250, v248, v249
  v_accvgpr_write_b32 a236, v250
  v_accvgpr_write_b32 a237, v251
  v_accvgpr_write_b32 a238, 0
  v_accvgpr_write_b32 a239, 0
  v_mfma_f32_32x32x16_bf16 v[144:159], v[196:199], v[212:215], v[144:159]
  v_cndmask_b32 v248, 0, v243, vcc
  v_sub_f32 v248, 0, v248
  v_cvt_pk_bf16_f32 v251, v248, 0
  v_lshlrev_b32 v249, 16, v251
  v_sub_f32 v249, v248, v249
  s_waitcnt lgkmcnt(0)
  v_mfma_f32_32x32x16_bf16 v[0:15], v[200:203], v[160:163], v[0:15]
  ds_read_b128 v[208:211], v224 offset:0
  ds_read_b128 v[212:215], v224 offset:4096
  v_cvt_pk_bf16_f32 v250, v248, v249
  v_accvgpr_write_b32 a240, v250
  v_accvgpr_write_b32 a241, v251
  v_mfma_f32_32x32x16_bf16 v[16:31], v[204:207], v[160:163], v[16:31]
  ds_read_b64_tr_b16 v[180:181], v216 offset:22528
  ds_read_b64_tr_b16 v[182:183], v216 offset:23040
  v_accvgpr_write_b32 a242, 0
  v_accvgpr_write_b32 a243, 0
  v_cndmask_b32 v248, 0, v244, vcc
  v_mfma_f32_32x32x16_bf16 v[32:47], v[200:203], v[164:167], v[32:47]
  ds_read_b64_tr_b16 v[184:185], v217 offset:22528
  ds_read_b64_tr_b16 v[186:187], v217 offset:23040
  v_sub_f32 v248, 0, v248
  v_cvt_pk_bf16_f32 v251, v248, 0
  v_lshlrev_b32 v249, 16, v251
  v_mfma_f32_32x32x16_bf16 v[48:63], v[204:207], v[164:167], v[48:63]
  ds_read_b64_tr_b16 v[188:189], v218 offset:22528
  ds_read_b64_tr_b16 v[190:191], v218 offset:23040
  v_sub_f32 v249, v248, v249
  v_cvt_pk_bf16_f32 v250, v248, v249
  v_accvgpr_write_b32 a244, v250
  v_mfma_f32_32x32x16_bf16 v[64:79], v[168:171], v[200:203], v[64:79]
  ds_read_b64_tr_b16 v[192:193], v219 offset:22528
  ds_read_b64_tr_b16 v[194:195], v219 offset:23040
  v_accvgpr_write_b32 a245, v251
  v_accvgpr_write_b32 a246, 0
  v_accvgpr_write_b32 a247, 0
  v_mfma_f32_32x32x16_bf16 v[80:95], v[168:171], v[204:207], v[80:95]
  ds_read_b64_tr_b16 v[196:197], v220 offset:21504
  ds_read_b64_tr_b16 v[198:199], v220 offset:21760
  v_cndmask_b32 v248, 0, v245, vcc
  v_sub_f32 v248, 0, v248
  v_cvt_pk_bf16_f32 v251, v248, 0
  v_mfma_f32_32x32x16_bf16 v[96:111], v[172:175], v[200:203], v[96:111]
  v_lshlrev_b32 v249, 16, v251
  v_sub_f32 v249, v248, v249
  v_cvt_pk_bf16_f32 v250, v248, v249
  v_accvgpr_write_b32 a248, v250
  v_accvgpr_write_b32 a249, v251
  v_mfma_f32_32x32x16_bf16 v[112:127], v[172:175], v[204:207], v[112:127]
  v_accvgpr_write_b32 a250, 0
  v_accvgpr_write_b32 a251, 0
  v_cndmask_b32 v248, 0, v246, vcc
  v_sub_f32 v248, 0, v248
  v_cvt_pk_bf16_f32 v251, v248, 0
  v_mfma_f32_32x32x16_bf16 v[128:143], v[176:179], v[200:203], v[128:143]
  v_lshlrev_b32 v249, 16, v251
  v_sub_f32 v249, v248, v249
  v_cvt_pk_bf16_f32 v250, v248, v249
  v_accvgpr_write_b32 a252, v250
  v_accvgpr_write_b32 a253, v251
  v_mfma_f32_32x32x16_bf16 v[144:159], v[176:179], v[204:207], v[144:159]
  v_accvgpr_write_b32 a254, 0
  v_accvgpr_write_b32 a255, 0
  v_lshlrev_b32 v248, 2, v238
  v_add_u32 v248, 159744, v248
  s_waitcnt lgkmcnt(0)
  v_mfma_f32_32x32x16_bf16 v[0:15], v[208:211], v[180:183], v[0:15]
  s_waitcnt vmcnt(2)
  s_barrier
  s_add_u32 m0, s52, 10240
  s_nop 0
  buffer_load_dwordx4 v239, s[48:51], s75 offen lds
  v_mfma_f32_32x32x16_bf16 v[16:31], v[212:215], v[180:183], v[16:31]
  ds_read_b128 v[200:203], v221 offset:16384
  s_add_u32 m0, s52, 11264
  ds_read_b128 v[204:207], v221 offset:20480
  buffer_load_dwordx4 v226, s[48:51], s75 offen lds
  v_mfma_f32_32x32x16_bf16 v[32:47], v[208:211], v[184:187], v[32:47]
  ds_read_b64_tr_b16 v[160:161], v216 offset:40960
  ds_read_b64_tr_b16 v[162:163], v216 offset:41472
  s_add_u32 s75, s75, 16384
  s_cmp_eq_u32 s75, 458752
  s_cselect_b32 s75, 0, s75
  v_mfma_f32_32x32x16_bf16 v[48:63], v[212:215], v[184:187], v[48:63]
  ds_read_b64_tr_b16 v[164:165], v217 offset:40960
  ds_read_b64_tr_b16 v[166:167], v217 offset:41472
  s_waitcnt vmcnt(28)
  ds_read_b64_tr_b16 a[152:153], v254 offset:2048
  ds_read_b64_tr_b16 a[154:155], v254 offset:3072
  v_mfma_f32_32x32x16_bf16 v[64:79], v[188:191], v[208:211], v[64:79]
  ds_read_b64_tr_b16 v[168:169], v218 offset:40960
  ds_read_b64_tr_b16 v[170:171], v218 offset:41472
  ds_read_b64_tr_b16 a[156:157], v255 offset:2048
  ds_read_b64_tr_b16 a[158:159], v255 offset:3072
  v_mfma_f32_32x32x16_bf16 v[80:95], v[188:191], v[212:215], v[80:95]
  ds_read_b64_tr_b16 v[172:173], v219 offset:40960
  s_add_u32 m0, s52, 0
  ds_read_b64_tr_b16 v[174:175], v219 offset:41472
  buffer_load_dwordx4 v239, s[48:51], s75 offen lds
  v_mfma_f32_32x32x16_bf16 v[96:111], v[192:195], v[208:211], v[96:111]
  ds_read_b64_tr_b16 v[176:177], v220 offset:40960
  s_add_u32 m0, s52, 1024
  ds_read_b64_tr_b16 v[178:179], v220 offset:41216
  buffer_load_dwordx4 v226, s[48:51], s75 offen lds
  v_mfma_f32_32x32x16_bf16 v[112:127], v[192:195], v[212:215], v[112:127]
  v_cmp_gt_u32 vcc, 128, v238
  s_and_saveexec_b64 s[60:61], vcc
  ds_write_b32 v248, v247
  s_mov_b64 exec, s[60:61]
  v_mfma_f32_32x32x16_bf16 v[128:143], v[196:199], v[208:211], v[128:143]
  s_add_u32 s39, s39, 32
  s_and_b32 s39, s39, 511
  s_add_u32 s40, s40, 32
  s_and_b32 s40, s40, 511
  v_mfma_f32_32x32x16_bf16 v[144:159], v[196:199], v[212:215], v[144:159]
  s_mul_i32 s41, s39, 3072
  s_mul_i32 s42, s39, 3584
  s_mul_i32 s43, s40, 3584
  s_add_u32 m0, s45, 49152
  s_nop 0
  buffer_load_dwordx4 v225, s[8:11], s41 offen lds
  s_waitcnt lgkmcnt(0)
  v_mfma_f32_32x32x16_bf16 v[0:15], a[228:231], a[236:239], v[0:15]
  s_add_u32 m0, s45, 53248
  s_nop 0
  buffer_load_dwordx4 v225, s[12:15], s41 offen lds
  v_mfma_f32_32x32x16_bf16 v[16:31], a[232:235], a[236:239], v[16:31]
  s_add_u32 m0, s45, 57344
  s_nop 0
  buffer_load_dwordx4 v227, s[16:19], s42 offen lds
  v_mfma_f32_32x32x16_bf16 v[32:47], a[228:231], a[240:243], v[32:47]
  s_add_u32 m0, s45, 61440
  s_nop 0
  buffer_load_dwordx4 v228, s[20:23], s42 offen lds
  v_mfma_f32_32x32x16_bf16 v[48:63], a[232:235], a[240:243], v[48:63]
  s_add_u32 m0, s45, 65536
  s_nop 0
  buffer_load_dwordx4 v229, s[24:27], s43 offen lds
  v_mfma_f32_32x32x16_bf16 v[64:79], a[244:247], a[228:231], v[64:79]
  s_add_u32 s75, s75, 16384
  s_cmp_eq_u32 s75, 458752
  s_cselect_b32 s75, 0, s75
  s_waitcnt vmcnt(19)
  v_mfma_f32_32x32x16_bf16 v[80:95], a[244:247], a[232:235], v[80:95]
  ds_read_b64_tr_b16 a[160:161], v254 offset:4096
  ds_read_b64_tr_b16 a[162:163], v254 offset:5120
  ds_read_b64_tr_b16 a[164:165], v255 offset:4096
  ds_read_b64_tr_b16 a[166:167], v255 offset:5120
  v_mfma_f32_32x32x16_bf16 v[96:111], a[248:251], a[228:231], v[96:111]
  s_add_u32 m0, s52, 2048
  s_nop 0
  buffer_load_dwordx4 v239, s[48:51], s75 offen lds
  v_mfma_f32_32x32x16_bf16 v[112:127], a[248:251], a[232:235], v[112:127]
  s_add_u32 m0, s52, 3072
  s_nop 0
  buffer_load_dwordx4 v226, s[48:51], s75 offen lds
  v_mfma_f32_32x32x16_bf16 v[128:143], a[252:255], a[228:231], v[128:143]
  s_add_u32 s75, s75, 16384
  s_cmp_eq_u32 s75, 458752
  s_cselect_b32 s75, 0, s75
  s_waitcnt vmcnt(18)
  v_mfma_f32_32x32x16_bf16 v[144:159], a[252:255], a[232:235], v[144:159]
  ds_read_b64_tr_b16 a[168:169], v254 offset:6144
  ds_read_b64_tr_b16 a[170:171], v254 offset:7168
  ds_read_b64_tr_b16 a[172:173], v255 offset:6144
  ds_read_b64_tr_b16 a[174:175], v255 offset:7168
  s_waitcnt lgkmcnt(0)
  v_mfma_f32_32x32x16_bf16 v[0:15], v[200:203], v[160:163], v[0:15]
  ds_read_b128 v[208:211], v222 offset:16384
  s_add_u32 m0, s52, 4096
  ds_read_b128 v[212:215], v222 offset:20480
  buffer_load_dwordx4 v239, s[48:51], s75 offen lds
  v_mfma_f32_32x32x16_bf16 v[16:31], v[204:207], v[160:163], v[16:31]
  ds_read_b64_tr_b16 v[180:181], v216 offset:43008
  s_add_u32 m0, s52, 5120
  ds_read_b64_tr_b16 v[182:183], v216 offset:43520
  buffer_load_dwordx4 v226, s[48:51], s75 offen lds
  v_mfma_f32_32x32x16_bf16 v[32:47], v[200:203], v[164:167], v[32:47]
  ds_read_b64_tr_b16 v[184:185], v217 offset:43008
  ds_read_b64_tr_b16 v[186:187], v217 offset:43520
  s_add_u32 s75, s75, 16384
  s_cmp_eq_u32 s75, 458752
  s_cselect_b32 s75, 0, s75
  v_mfma_f32_32x32x16_bf16 v[48:63], v[204:207], v[164:167], v[48:63]
  ds_read_b64_tr_b16 v[188:189], v218 offset:43008
  ds_read_b64_tr_b16 v[190:191], v218 offset:43520
  s_waitcnt vmcnt(13)
  ds_read_b64_tr_b16 a[176:177], v254 offset:8192
  ds_read_b64_tr_b16 a[178:179], v254 offset:9216
  v_mfma_f32_32x32x16_bf16 v[64:79], v[168:171], v[200:203], v[64:79]
  ds_read_b64_tr_b16 v[192:193], v219 offset:43008
  ds_read_b64_tr_b16 v[194:195], v219 offset:43520
  ds_read_b64_tr_b16 a[180:181], v255 offset:8192
  ds_read_b64_tr_b16 a[182:183], v255 offset:9216
  v_mfma_f32_32x32x16_bf16 v[80:95], v[168:171], v[204:207], v[80:95]
  ds_read_b64_tr_b16 v[196:197], v220 offset:41984
  s_add_u32 m0, s52, 6144
  ds_read_b64_tr_b16 v[198:199], v220 offset:42240
  buffer_load_dwordx4 v239, s[48:51], s75 offen lds
  v_mfma_f32_32x32x16_bf16 v[96:111], v[172:175], v[200:203], v[96:111]
  s_add_u32 m0, s52, 7168
  s_nop 0
  buffer_load_dwordx4 v226, s[48:51], s75 offen lds
  v_mfma_f32_32x32x16_bf16 v[112:127], v[172:175], v[204:207], v[112:127]
  v_mfma_f32_32x32x16_bf16 v[128:143], v[176:179], v[200:203], v[128:143]
  v_mfma_f32_32x32x16_bf16 v[144:159], v[176:179], v[204:207], v[144:159]
  s_waitcnt lgkmcnt(0)
  v_mfma_f32_32x32x16_bf16 v[0:15], v[208:211], v[180:183], v[0:15]
  s_waitcnt vmcnt(6)
  s_barrier
  s_waitcnt vmcnt(13)
  ds_read_b64_tr_b16 a[184:185], v254 offset:10240
  ds_read_b64_tr_b16 a[186:187], v254 offset:11264
  v_mfma_f32_32x32x16_bf16 v[16:31], v[212:215], v[180:183], v[16:31]
  ds_read_b128 v[200:203], v223 offset:16384
  ds_read_b128 v[204:207], v223 offset:20480
  ds_read_b64_tr_b16 a[188:189], v255 offset:10240
  ds_read_b64_tr_b16 a[190:191], v255 offset:11264
  v_mfma_f32_32x32x16_bf16 v[32:47], v[208:211], v[184:187], v[32:47]
  ds_read_b64_tr_b16 v[160:161], v216 offset:0
  ds_read_b64_tr_b16 v[162:163], v216 offset:512
  v_mfma_f32_32x32x16_bf16 v[48:63], v[212:215], v[184:187], v[48:63]
  ds_read_b64_tr_b16 v[164:165], v217 offset:0
  ds_read_b64_tr_b16 v[166:167], v217 offset:512
  v_mfma_f32_32x32x16_bf16 v[64:79], v[188:191], v[208:211], v[64:79]
  ds_read_b64_tr_b16 v[168:169], v218 offset:0
  ds_read_b64_tr_b16 v[170:171], v218 offset:512
  v_mfma_f32_32x32x16_bf16 v[80:95], v[188:191], v[212:215], v[80:95]
  ds_read_b64_tr_b16 v[172:173], v219 offset:0
  ds_read_b64_tr_b16 v[174:175], v219 offset:512
  v_mfma_f32_32x32x16_bf16 v[96:111], v[192:195], v[208:211], v[96:111]
  ds_read_b64_tr_b16 v[176:177], v220 offset:0
  ds_read_b64_tr_b16 v[178:179], v220 offset:256
  v_mfma_f32_32x32x16_bf16 v[112:127], v[192:195], v[212:215], v[112:127]
  v_mfma_f32_32x32x16_bf16 v[128:143], v[196:199], v[208:211], v[128:143]
  v_mfma_f32_32x32x16_bf16 v[144:159], v[196:199], v[212:215], v[144:159]
  s_waitcnt lgkmcnt(0)
  v_mfma_f32_32x32x16_bf16 v[0:15], v[200:203], v[160:163], v[0:15]
  ds_read_b128 v[208:211], v224 offset:16384
  ds_read_b128 v[212:215], v224 offset:20480
  s_waitcnt vmcnt(11)
  ds_read_b64_tr_b16 a[192:193], v254 offset:0
  ds_read_b64_tr_b16 a[194:195], v254 offset:1024
  v_mfma_f32_32x32x16_bf16 v[16:31], v[204:207], v[160:163], v[16:31]
  ds_read_b64_tr_b16 v[180:181], v216 offset:2048
  ds_read_b64_tr_b16 v[182:183], v216 offset:2560
  ds_read_b64_tr_b16 a[196:197], v255 offset:0
  ds_read_b64_tr_b16 a[198:199], v255 offset:1024
  v_mfma_f32_32x32x16_bf16 v[32:47], v[200:203], v[164:167], v[32:47]
  ds_read_b64_tr_b16 v[184:185], v217 offset:2048
  ds_read_b64_tr_b16 v[186:187], v217 offset:2560
  v_mfma_f32_32x32x16_bf16 v[48:63], v[204:207], v[164:167], v[48:63]
  ds_read_b64_tr_b16 v[188:189], v218 offset:2048
  ds_read_b64_tr_b16 v[190:191], v218 offset:2560
  v_mfma_f32_32x32x16_bf16 v[64:79], v[168:171], v[200:203], v[64:79]
  ds_read_b64_tr_b16 v[192:193], v219 offset:2048
  ds_read_b64_tr_b16 v[194:195], v219 offset:2560
  v_mfma_f32_32x32x16_bf16 v[80:95], v[168:171], v[204:207], v[80:95]
  ds_read_b64_tr_b16 v[196:197], v220 offset:1024
  ds_read_b64_tr_b16 v[198:199], v220 offset:1280
  v_mfma_f32_32x32x16_bf16 v[96:111], v[172:175], v[200:203], v[96:111]
  v_mfma_f32_32x32x16_bf16 v[112:127], v[172:175], v[204:207], v[112:127]
  v_mfma_f32_32x32x16_bf16 v[128:143], v[176:179], v[200:203], v[128:143]
  v_mfma_f32_32x32x16_bf16 v[144:159], v[176:179], v[204:207], v[144:159]
  s_waitcnt lgkmcnt(0)
  v_mfma_f32_32x32x16_bf16 v[64:79], v[188:191], v[208:211], v[64:79]
  s_barrier
  s_waitcnt vmcnt(4)
  ds_read_b64_tr_b16 a[200:201], v254 offset:2048
  ds_read_b64_tr_b16 a[202:203], v254 offset:3072
  v_mfma_f32_32x32x16_bf16 v[80:95], v[188:191], v[212:215], v[80:95]
  ds_read_b64_tr_b16 a[204:205], v255 offset:2048
  ds_read_b64_tr_b16 a[206:207], v255 offset:3072
  s_waitcnt vmcnt(2)
  ds_read_b64_tr_b16 a[208:209], v254 offset:4096
  ds_read_b64_tr_b16 a[210:211], v254 offset:5120
  v_mfma_f32_32x32x16_bf16 v[96:111], v[192:195], v[208:211], v[96:111]
  ds_read_b64_tr_b16 a[212:213], v255 offset:4096
  ds_read_b64_tr_b16 a[214:215], v255 offset:5120
  s_waitcnt vmcnt(0)
  ds_read_b64_tr_b16 a[216:217], v254 offset:6144
  ds_read_b64_tr_b16 a[218:219], v254 offset:7168
  v_mfma_f32_32x32x16_bf16 v[112:127], v[192:195], v[212:215], v[112:127]
  ds_read_b64_tr_b16 a[220:221], v255 offset:6144
  ds_read_b64_tr_b16 a[222:223], v255 offset:7168
  v_mfma_f32_32x32x16_bf16 v[128:143], v[196:199], v[208:211], v[128:143]
  v_mfma_f32_32x32x16_bf16 v[144:159], v[196:199], v[212:215], v[144:159]
  v_mfma_f32_32x32x16_bf16 v[0:15], v[208:211], v[180:183], v[0:15]
  v_mfma_f32_32x32x16_bf16 v[16:31], v[212:215], v[180:183], v[16:31]
  v_mfma_f32_32x32x16_bf16 v[32:47], v[208:211], v[184:187], v[32:47]
  v_mfma_f32_32x32x16_bf16 v[48:63], v[212:215], v[184:187], v[48:63]
  s_waitcnt lgkmcnt(0)
  s_barrier
  s_mul_i32 s54, s34, 22528
  s_add_u32 s54, s54, 69632
  s_sub_u32 s55, s54, s52
  s_mov_b32 s52, s54
  v_add_u32 v254, s55, v254
  v_xor_b32 v255, 64, v254
  s_lshl_b32 s54, s70, 7
  s_lshl_b32 s55, s34, 17
  s_add_u32 s54, s54, s55
  s_add_u32 s8, s68, s54
  s_addc_u32 s9, s69, 0
  s_and_b32 s9, s9, 0xffff
  s_sub_u32 s10, 524288, s54
  s_mov_b32 s11, 0x20000
  s_lshl_b32 s54, s37, 1
  s_add_u32 s54, s54, s35
  s_lshl_b32 s54, s54, 2
  s_lshr_b32 s55, s38, 1
  s_add_u32 s54, s54, s55
  s_mul_i32 s80, s54, 73728
  s_and_b32 s81, s38, 1
  v_mul_f32 v200, v234, v234
  v_mul_f32 v201, v234, v234
  v_mul_f32 v202, v235, v235
  v_mul_f32 v203, v235, v235
  s_lshl_b32 s56, s81, 2
  s_lshl_b32 s57, s36, 1
  s_add_u32 s56, s56, s57
  s_add_u32 s56, s56, 16
  s_lshl_b32 s56, s56, 11
  s_add_u32 s56, s56, s80
  v_pk_mul_f32 v[64:65], v[64:65], v[72:73]
  v_pk_mul_f32 v[66:67], v[66:67], v[74:75]
  v_pk_mul_f32 v[68:69], v[68:69], v[76:77]
  v_pk_mul_f32 v[70:71], v[70:71], v[78:79]
  v_pk_mul_f32 v[64:65], v[64:65], v[200:201]
  v_pk_mul_f32 v[66:67], v[66:67], v[200:201]
  v_pk_mul_f32 v[68:69], v[68:69], v[200:201]
  v_pk_mul_f32 v[70:71], v[70:71], v[200:201]
  v_cvt_pk_bf16_f32 v160, v64, v65
  v_cvt_pk_bf16_f32 v161, v66, v67
  v_cvt_pk_bf16_f32 v162, v68, v69
  v_cvt_pk_bf16_f32 v163, v70, v71
  buffer_store_dwordx4 v[160:163], v237, s[28:31], s56 offen offset:0 sc1
  v_pk_mul_f32 v[80:81], v[80:81], v[88:89]
  v_pk_mul_f32 v[82:83], v[82:83], v[90:91]
  v_pk_mul_f32 v[84:85], v[84:85], v[92:93]
  v_pk_mul_f32 v[86:87], v[86:87], v[94:95]
  v_pk_mul_f32 v[80:81], v[80:81], v[202:203]
  v_pk_mul_f32 v[82:83], v[82:83], v[202:203]
  v_pk_mul_f32 v[84:85], v[84:85], v[202:203]
  v_pk_mul_f32 v[86:87], v[86:87], v[202:203]
  v_cvt_pk_bf16_f32 v164, v80, v81
  v_cvt_pk_bf16_f32 v165, v82, v83
  v_cvt_pk_bf16_f32 v166, v84, v85
  v_cvt_pk_bf16_f32 v167, v86, v87
  buffer_store_dwordx4 v[164:167], v237, s[28:31], s56 offen offset:1024 sc1
  s_add_u32 s56, s56, 2048
  v_pk_mul_f32 v[96:97], v[96:97], v[104:105]
  v_pk_mul_f32 v[98:99], v[98:99], v[106:107]
  v_pk_mul_f32 v[100:101], v[100:101], v[108:109]
  v_pk_mul_f32 v[102:103], v[102:103], v[110:111]
  v_pk_mul_f32 v[96:97], v[96:97], v[200:201]
  v_pk_mul_f32 v[98:99], v[98:99], v[200:201]
  v_pk_mul_f32 v[100:101], v[100:101], v[200:201]
  v_pk_mul_f32 v[102:103], v[102:103], v[200:201]
  v_cvt_pk_bf16_f32 v168, v96, v97
  v_cvt_pk_bf16_f32 v169, v98, v99
  v_cvt_pk_bf16_f32 v170, v100, v101
  v_cvt_pk_bf16_f32 v171, v102, v103
  buffer_store_dwordx4 v[168:171], v237, s[28:31], s56 offen offset:0 sc1
  v_pk_mul_f32 v[112:113], v[112:113], v[120:121]
  v_pk_mul_f32 v[114:115], v[114:115], v[122:123]
  v_pk_mul_f32 v[116:117], v[116:117], v[124:125]
  v_pk_mul_f32 v[118:119], v[118:119], v[126:127]
  v_pk_mul_f32 v[112:113], v[112:113], v[202:203]
  v_pk_mul_f32 v[114:115], v[114:115], v[202:203]
  v_pk_mul_f32 v[116:117], v[116:117], v[202:203]
  v_pk_mul_f32 v[118:119], v[118:119], v[202:203]
  v_cvt_pk_bf16_f32 v172, v112, v113
  v_cvt_pk_bf16_f32 v173, v114, v115
  v_cvt_pk_bf16_f32 v174, v116, v117
  v_cvt_pk_bf16_f32 v175, v118, v119
  buffer_store_dwordx4 v[172:175], v237, s[28:31], s56 offen offset:1024 sc1
  s_lshl_b32 s56, s81, 1
  s_add_u32 s56, s56, s36
  s_add_u32 s56, s56, 24
  s_lshl_b32 s56, s56, 11
  s_add_u32 s56, s56, s80
  v_pk_mul_f32 v[128:129], v[128:129], v[136:137]
  v_pk_mul_f32 v[130:131], v[130:131], v[138:139]
  v_pk_mul_f32 v[132:133], v[132:133], v[140:141]
  v_pk_mul_f32 v[134:135], v[134:135], v[142:143]
  v_pk_mul_f32 v[128:129], v[128:129], v[200:201]
  v_pk_mul_f32 v[130:131], v[130:131], v[200:201]
  v_pk_mul_f32 v[132:133], v[132:133], v[200:201]
  v_pk_mul_f32 v[134:135], v[134:135], v[200:201]
  v_cvt_pk_bf16_f32 v160, v128, v129
  v_cvt_pk_bf16_f32 v161, v130, v131
  v_cvt_pk_bf16_f32 v162, v132, v133
  v_cvt_pk_bf16_f32 v163, v134, v135
  buffer_store_dwordx4 v[160:163], v237, s[28:31], s56 offen offset:0 sc1
  v_pk_mul_f32 v[144:145], v[144:145], v[152:153]
  v_pk_mul_f32 v[146:147], v[146:147], v[154:155]
  v_pk_mul_f32 v[148:149], v[148:149], v[156:157]
  v_pk_mul_f32 v[150:151], v[150:151], v[158:159]
  v_pk_mul_f32 v[144:145], v[144:145], v[202:203]
  v_pk_mul_f32 v[146:147], v[146:147], v[202:203]
  v_pk_mul_f32 v[148:149], v[148:149], v[202:203]
  v_pk_mul_f32 v[150:151], v[150:151], v[202:203]
  v_cvt_pk_bf16_f32 v164, v144, v145
  v_cvt_pk_bf16_f32 v165, v146, v147
  v_cvt_pk_bf16_f32 v166, v148, v149
  v_cvt_pk_bf16_f32 v167, v150, v151
  buffer_store_dwordx4 v[164:167], v237, s[28:31], s56 offen offset:1024 sc1
  s_mov_b32 s20, 0x358637bd
  s_mov_b32 s21, 0x358637bd
  v_mov_b32 v204, 0x3f803f80
  v_mov_b32 v205, 0x3f803f80
  v_mov_b32 v206, 0x3f803f80
  v_mov_b32 v207, 0x3f803f80
  v_lshrrev_b32 v240, 5, v236
  v_lshlrev_b32 v240, 4, v240
  s_lshl_b32 s54, s35, 8
  s_add_u32 s54, s54, 159744
  v_add_u32 v209, s54, v240
  ds_read_b128 v[160:163], v209 offset:0
  ds_read_b128 v[164:167], v209 offset:32
  ds_read_b128 v[168:171], v209 offset:64
  ds_read_b128 v[172:175], v209 offset:96
  s_waitcnt lgkmcnt(0)
  s_mov_b32 s54, 0x3fb8aa3b
  s_mov_b32 s55, 0x3fb8aa3b
  v_pk_mul_f32 v[176:177], v[160:161], s[54:55]
  v_pk_mul_f32 v[178:179], v[162:163], s[54:55]
  v_pk_mul_f32 v[180:181], v[164:165], s[54:55]
  v_pk_mul_f32 v[182:183], v[166:167], s[54:55]
  v_pk_mul_f32 v[184:185], v[168:169], s[54:55]
  v_pk_mul_f32 v[186:187], v[170:171], s[54:55]
  v_pk_mul_f32 v[188:189], v[172:173], s[54:55]
  v_pk_mul_f32 v[190:191], v[174:175], s[54:55]
  v_pk_mul_f32 v[240:241], v[0:1], v[176:177]
  v_pk_mul_f32 v[242:243], v[2:3], v[178:179]
  v_pk_fma_f32 v[0:1], v[0:1], v[160:161], s[20:21]
  v_pk_fma_f32 v[2:3], v[2:3], v[162:163], s[20:21]
  v_exp_f32_e64 v240, v240 clamp
  v_exp_f32_e64 v241, v241 clamp
  v_exp_f32_e64 v242, v242 clamp
  v_exp_f32_e64 v243, v243 clamp
  v_max_f32 v0, s20, v0
  v_max_f32 v1, s20, v1
  v_max_f32 v2, s20, v2
  v_max_f32 v3, s20, v3
  v_pk_add_f32 v[0:1], v[0:1], v[240:241]
  v_pk_add_f32 v[2:3], v[2:3], v[242:243]
  v_pk_mul_f32 v[240:241], v[4:5], v[180:181]
  v_pk_mul_f32 v[242:243], v[6:7], v[182:183]
  v_pk_fma_f32 v[4:5], v[4:5], v[164:165], s[20:21]
  v_pk_fma_f32 v[6:7], v[6:7], v[166:167], s[20:21]
  v_exp_f32_e64 v240, v240 clamp
  v_exp_f32_e64 v241, v241 clamp
  v_exp_f32_e64 v242, v242 clamp
  v_exp_f32_e64 v243, v243 clamp
  v_max_f32 v4, s20, v4
  v_max_f32 v5, s20, v5
  v_max_f32 v6, s20, v6
  v_max_f32 v7, s20, v7
  v_pk_add_f32 v[4:5], v[4:5], v[240:241]
  v_pk_add_f32 v[6:7], v[6:7], v[242:243]
  v_pk_mul_f32 v[240:241], v[8:9], v[184:185]
  v_pk_mul_f32 v[242:243], v[10:11], v[186:187]
  v_pk_fma_f32 v[8:9], v[8:9], v[168:169], s[20:21]
  v_pk_fma_f32 v[10:11], v[10:11], v[170:171], s[20:21]
  v_exp_f32_e64 v240, v240 clamp
  v_exp_f32_e64 v241, v241 clamp
  v_exp_f32_e64 v242, v242 clamp
  v_exp_f32_e64 v243, v243 clamp
  v_max_f32 v8, s20, v8
  v_max_f32 v9, s20, v9
  v_max_f32 v10, s20, v10
  v_max_f32 v11, s20, v11
  v_pk_add_f32 v[8:9], v[8:9], v[240:241]
  v_pk_add_f32 v[10:11], v[10:11], v[242:243]
  v_pk_mul_f32 v[240:241], v[12:13], v[188:189]
  v_pk_mul_f32 v[242:243], v[14:15], v[190:191]
  v_pk_fma_f32 v[12:13], v[12:13], v[172:173], s[20:21]
  v_pk_fma_f32 v[14:15], v[14:15], v[174:175], s[20:21]
  v_exp_f32_e64 v240, v240 clamp
  v_exp_f32_e64 v241, v241 clamp
  v_exp_f32_e64 v242, v242 clamp
  v_exp_f32_e64 v243, v243 clamp
  v_max_f32 v12, s20, v12
  v_max_f32 v13, s20, v13
  v_max_f32 v14, s20, v14
  v_max_f32 v15, s20, v15
  v_pk_add_f32 v[12:13], v[12:13], v[240:241]
  v_pk_add_f32 v[14:15], v[14:15], v[242:243]
  v_pk_mul_f32 v[32:33], v[32:33], v[160:161]
  v_pk_mul_f32 v[34:35], v[34:35], v[162:163]
  v_pk_mul_f32 v[36:37], v[36:37], v[164:165]
  v_pk_mul_f32 v[38:39], v[38:39], v[166:167]
  v_pk_mul_f32 v[40:41], v[40:41], v[168:169]
  v_pk_mul_f32 v[42:43], v[42:43], v[170:171]
  v_pk_mul_f32 v[44:45], v[44:45], v[172:173]
  v_pk_mul_f32 v[46:47], v[46:47], v[174:175]
  v_cvt_pk_bf16_f32 v192, v0, v1
  v_cvt_pk_bf16_f32 v193, v2, v3
  v_cvt_pk_bf16_f32 v194, v4, v5
  v_cvt_pk_bf16_f32 v195, v6, v7
  v_cvt_pk_bf16_f32 v196, v8, v9
  v_cvt_pk_bf16_f32 v197, v10, v11
  v_cvt_pk_bf16_f32 v198, v12, v13
  v_cvt_pk_bf16_f32 v199, v14, v15
  v_cvt_pk_bf16_f32 v246, v32, v33
  v_cvt_pk_bf16_f32 v247, v34, v35
  v_cvt_pk_bf16_f32 v248, v36, v37
  v_cvt_pk_bf16_f32 v249, v38, v39
  v_cvt_pk_bf16_f32 v250, v40, v41
  v_cvt_pk_bf16_f32 v251, v42, v43
  v_cvt_pk_bf16_f32 v252, v44, v45
  v_cvt_pk_bf16_f32 v253, v46, v47
  s_nop 1
  v_mfma_f32_32x32x16_bf16 v[64:79], v[192:195], v[246:249], 0
  v_mfma_f32_32x32x16_bf16 v[80:95], v[192:195], v[204:207], 0
  v_mfma_f32_32x32x16_bf16 v[64:79], v[196:199], v[250:253], v[64:79]
  v_mfma_f32_32x32x16_bf16 v[80:95], v[196:199], v[204:207], v[80:95]
  ds_read_b128 v[160:163], v209 offset:128
  ds_read_b128 v[164:167], v209 offset:160
  ds_read_b128 v[168:171], v209 offset:192
  ds_read_b128 v[172:175], v209 offset:224
  s_waitcnt lgkmcnt(0)
  s_mov_b32 s54, 0x3fb8aa3b
  s_mov_b32 s55, 0x3fb8aa3b
  v_pk_mul_f32 v[176:177], v[160:161], s[54:55]
  v_pk_mul_f32 v[178:179], v[162:163], s[54:55]
  v_pk_mul_f32 v[180:181], v[164:165], s[54:55]
  v_pk_mul_f32 v[182:183], v[166:167], s[54:55]
  v_pk_mul_f32 v[184:185], v[168:169], s[54:55]
  v_pk_mul_f32 v[186:187], v[170:171], s[54:55]
  v_pk_mul_f32 v[188:189], v[172:173], s[54:55]
  v_pk_mul_f32 v[190:191], v[174:175], s[54:55]
  v_pk_mul_f32 v[240:241], v[16:17], v[176:177]
  v_pk_mul_f32 v[242:243], v[18:19], v[178:179]
  v_pk_fma_f32 v[16:17], v[16:17], v[160:161], s[20:21]
  v_pk_fma_f32 v[18:19], v[18:19], v[162:163], s[20:21]
  v_exp_f32_e64 v240, v240 clamp
  v_exp_f32_e64 v241, v241 clamp
  v_exp_f32_e64 v242, v242 clamp
  v_exp_f32_e64 v243, v243 clamp
  v_max_f32 v16, s20, v16
  v_max_f32 v17, s20, v17
  v_max_f32 v18, s20, v18
  v_max_f32 v19, s20, v19
  v_pk_add_f32 v[16:17], v[16:17], v[240:241]
  v_pk_add_f32 v[18:19], v[18:19], v[242:243]
  v_pk_mul_f32 v[240:241], v[20:21], v[180:181]
  v_pk_mul_f32 v[242:243], v[22:23], v[182:183]
  v_pk_fma_f32 v[20:21], v[20:21], v[164:165], s[20:21]
  v_pk_fma_f32 v[22:23], v[22:23], v[166:167], s[20:21]
  v_exp_f32_e64 v240, v240 clamp
  v_exp_f32_e64 v241, v241 clamp
  v_exp_f32_e64 v242, v242 clamp
  v_exp_f32_e64 v243, v243 clamp
  v_max_f32 v20, s20, v20
  v_max_f32 v21, s20, v21
  v_max_f32 v22, s20, v22
  v_max_f32 v23, s20, v23
  v_pk_add_f32 v[20:21], v[20:21], v[240:241]
  v_pk_add_f32 v[22:23], v[22:23], v[242:243]
  v_pk_mul_f32 v[240:241], v[24:25], v[184:185]
  v_pk_mul_f32 v[242:243], v[26:27], v[186:187]
  v_pk_fma_f32 v[24:25], v[24:25], v[168:169], s[20:21]
  v_pk_fma_f32 v[26:27], v[26:27], v[170:171], s[20:21]
  v_exp_f32_e64 v240, v240 clamp
  v_exp_f32_e64 v241, v241 clamp
  v_exp_f32_e64 v242, v242 clamp
  v_exp_f32_e64 v243, v243 clamp
  v_max_f32 v24, s20, v24
  v_max_f32 v25, s20, v25
  v_max_f32 v26, s20, v26
  v_max_f32 v27, s20, v27
  v_pk_add_f32 v[24:25], v[24:25], v[240:241]
  v_pk_add_f32 v[26:27], v[26:27], v[242:243]
  v_pk_mul_f32 v[240:241], v[28:29], v[188:189]
  v_pk_mul_f32 v[242:243], v[30:31], v[190:191]
  v_pk_fma_f32 v[28:29], v[28:29], v[172:173], s[20:21]
  v_pk_fma_f32 v[30:31], v[30:31], v[174:175], s[20:21]
  v_exp_f32_e64 v240, v240 clamp
  v_exp_f32_e64 v241, v241 clamp
  v_exp_f32_e64 v242, v242 clamp
  v_exp_f32_e64 v243, v243 clamp
  v_max_f32 v28, s20, v28
  v_max_f32 v29, s20, v29
  v_max_f32 v30, s20, v30
  v_max_f32 v31, s20, v31
  v_pk_add_f32 v[28:29], v[28:29], v[240:241]
  v_pk_add_f32 v[30:31], v[30:31], v[242:243]
  v_pk_mul_f32 v[48:49], v[48:49], v[160:161]
  v_pk_mul_f32 v[50:51], v[50:51], v[162:163]
  v_pk_mul_f32 v[52:53], v[52:53], v[164:165]
  v_pk_mul_f32 v[54:55], v[54:55], v[166:167]
  v_pk_mul_f32 v[56:57], v[56:57], v[168:169]
  v_pk_mul_f32 v[58:59], v[58:59], v[170:171]
  v_pk_mul_f32 v[60:61], v[60:61], v[172:173]
  v_pk_mul_f32 v[62:63], v[62:63], v[174:175]
  v_cvt_pk_bf16_f32 v192, v16, v17
  v_cvt_pk_bf16_f32 v193, v18, v19
  v_cvt_pk_bf16_f32 v194, v20, v21
  v_cvt_pk_bf16_f32 v195, v22, v23
  v_cvt_pk_bf16_f32 v196, v24, v25
  v_cvt_pk_bf16_f32 v197, v26, v27
  v_cvt_pk_bf16_f32 v198, v28, v29
  v_cvt_pk_bf16_f32 v199, v30, v31
  v_cvt_pk_bf16_f32 v246, v48, v49
  v_cvt_pk_bf16_f32 v247, v50, v51
  v_cvt_pk_bf16_f32 v248, v52, v53
  v_cvt_pk_bf16_f32 v249, v54, v55
  v_cvt_pk_bf16_f32 v250, v56, v57
  v_cvt_pk_bf16_f32 v251, v58, v59
  v_cvt_pk_bf16_f32 v252, v60, v61
  v_cvt_pk_bf16_f32 v253, v62, v63
  s_nop 1
  v_mfma_f32_32x32x16_bf16 v[64:79], v[192:195], v[246:249], v[64:79]
  v_mfma_f32_32x32x16_bf16 v[80:95], v[192:195], v[204:207], v[80:95]
  v_mfma_f32_32x32x16_bf16 v[64:79], v[196:199], v[250:253], v[64:79]
  v_mfma_f32_32x32x16_bf16 v[80:95], v[196:199], v[204:207], v[80:95]
  v_mov_b32 v245, 1
  s_lshl_b32 s54, s37, 1
  s_add_u32 s54, s54, s35
  s_lshl_b32 s54, s54, 2
  s_lshr_b32 s55, s38, 1
  s_add_u32 s54, s54, s55
  s_lshl_b32 s54, s54, 4
  s_lshl_b32 s55, s81, 1
  s_add_u32 s54, s54, s55
  s_add_u32 s54, s54, s36
  s_add_u32 s54, s54, 4
  s_lshl_b32 s54, s54, 2
  s_add_u32 s54, s54, 69632
  v_mov_b32 v244, s54
  s_mov_b64 s[60:61], exec
  s_mov_b64 exec, 1
  s_waitcnt vmcnt(0)
  global_store_dword v244, v245, s[32:33] sc1
  s_mov_b64 exec, s[60:61]
  s_mov_b32 s53, 0
  s_add_u32 m0, s52, 0
  s_nop 0
  buffer_load_dwordx4 v239, s[8:11], s53 offen lds
  s_add_u32 m0, s52, 1024
  s_nop 0
  buffer_load_dwordx4 v226, s[8:11], s53 offen lds
  s_mov_b32 s53, 16384
  s_add_u32 m0, s52, 2048
  s_nop 0
  buffer_load_dwordx4 v239, s[8:11], s53 offen lds
  s_add_u32 m0, s52, 3072
  s_nop 0
  buffer_load_dwordx4 v226, s[8:11], s53 offen lds
  s_mov_b32 s53, 32768
  s_add_u32 m0, s52, 4096
  s_nop 0
  buffer_load_dwordx4 v239, s[8:11], s53 offen lds
  s_add_u32 m0, s52, 5120
  s_nop 0
  buffer_load_dwordx4 v226, s[8:11], s53 offen lds
  s_mov_b32 s53, 49152
  s_add_u32 m0, s52, 6144
  s_nop 0
  buffer_load_dwordx4 v239, s[8:11], s53 offen lds
  s_add_u32 m0, s52, 7168
  s_nop 0
  buffer_load_dwordx4 v226, s[8:11], s53 offen lds
  s_mov_b32 s53, 65536
  s_add_u32 m0, s52, 8192
  s_nop 0
  buffer_load_dwordx4 v239, s[8:11], s53 offen lds
  s_add_u32 m0, s52, 9216
  s_nop 0
  buffer_load_dwordx4 v226, s[8:11], s53 offen lds
  s_mov_b32 s53, 81920
  s_add_u32 m0, s52, 10240
  s_nop 0
  buffer_load_dwordx4 v239, s[8:11], s53 offen lds
  s_add_u32 m0, s52, 11264
  s_nop 0
  buffer_load_dwordx4 v226, s[8:11], s53 offen lds
  s_mov_b32 s53, 98304
  s_add_u32 m0, s52, 12288
  s_nop 0
  buffer_load_dwordx4 v239, s[8:11], s53 offen lds
  s_add_u32 m0, s52, 13312
  s_nop 0
  buffer_load_dwordx4 v226, s[8:11], s53 offen lds
  s_mov_b32 s53, 114688
  s_add_u32 m0, s52, 14336
  s_nop 0
  buffer_load_dwordx4 v239, s[8:11], s53 offen lds
  s_add_u32 m0, s52, 15360
  s_nop 0
  buffer_load_dwordx4 v226, s[8:11], s53 offen lds
  v_and_b32 v240, 31, v236
  v_cmp_gt_u32 vcc, 16, v240
  s_lshl_b32 s54, s35, 13
  s_lshl_b32 s55, s36, 12
  s_add_u32 s54, s54, s55
  s_add_u32 s54, s54, 0
  v_lshlrev_b32 v240, 2, v236
  v_add_u32 v240, s54, v240
  s_nop 7
  s_nop 3
  v_cndmask_b32 v64, v80, v64, vcc
  v_cndmask_b32 v65, v81, v65, vcc
  v_cndmask_b32 v66, v82, v66, vcc
  v_cndmask_b32 v67, v83, v67, vcc
  v_cndmask_b32 v68, v84, v68, vcc
  v_cndmask_b32 v69, v85, v69, vcc
  v_cndmask_b32 v70, v86, v70, vcc
  v_cndmask_b32 v71, v87, v71, vcc
  v_cndmask_b32 v72, v72, v88, vcc
  v_cndmask_b32 v73, v73, v89, vcc
  v_cndmask_b32 v74, v74, v90, vcc
  v_cndmask_b32 v75, v75, v91, vcc
  v_cndmask_b32 v76, v76, v92, vcc
  v_cndmask_b32 v77, v77, v93, vcc
  v_cndmask_b32 v78, v78, v94, vcc
  v_cndmask_b32 v79, v79, v95, vcc
  ds_write_b32 v240, v64 offset:0
  ds_write_b32 v240, v65 offset:256
  ds_write_b32 v240, v66 offset:512
  ds_write_b32 v240, v67 offset:768
  ds_write_b32 v240, v68 offset:1024
  ds_write_b32 v240, v69 offset:1280
  ds_write_b32 v240, v70 offset:1536
  ds_write_b32 v240, v71 offset:1792
  ds_write_b32 v240, v72 offset:2048
  ds_write_b32 v240, v73 offset:2304
  ds_write_b32 v240, v74 offset:2560
  ds_write_b32 v240, v75 offset:2816
  ds_write_b32 v240, v76 offset:3072
  ds_write_b32 v240, v77 offset:3328
  ds_write_b32 v240, v78 offset:3584
  ds_write_b32 v240, v79 offset:3840
  s_waitcnt lgkmcnt(0)
  s_barrier
  s_lshr_b32 s54, s34, 1
  s_lshl_b32 s54, s54, 12
  s_add_u32 s54, s54, 0
  s_and_b32 s56, s34, 1
  s_mul_i32 s57, s56, 2048
  s_add_u32 s54, s54, s57
  s_lshl_b32 s57, s56, 6
  s_lshl_b32 s55, s38, 2
  s_add_u32 s55, s55, s34
  s_mul_i32 s55, s55, 1152
  s_add_u32 s55, s55, 32768
  v_and_b32 v240, 7, v236
  v_lshlrev_b32 v240, 8, v240
  v_add_u32 v240, s54, v240
  v_lshrrev_b32 v241, 3, v236
  v_lshlrev_b32 v241, 2, v241
  v_add_u32 v242, v240, v241
  v_add_u32 v242, s57, v242
  ds_read_b32 v0, v242 offset:0
  ds_read_b32 v1, v242 offset:8192
  ds_read_b32 v2, v242 offset:32
  ds_read_b32 v3, v242 offset:8224
  ds_read_b32 v4, v242 offset:128
  ds_read_b32 v5, v242 offset:8320
  ds_read_b32 v6, v242 offset:160
  ds_read_b32 v7, v242 offset:8352
  s_sub_u32 s57, 64, s57
  v_lshlrev_b32 v243, 5, v241
  v_add_u32 v243, v243, v240
  v_add_u32 v243, s57, v243
  v_cmp_gt_u32 vcc, 16, v236
  s_and_saveexec_b64 s[60:61], vcc
  ds_read_b32 v8, v243
  ds_read_b32 v9, v243 offset:8192
  s_mov_b64 exec, s[60:61]
  v_lshlrev_b32 v242, 2, v236
  v_add_u32 v242, s55, v242
  s_waitcnt lgkmcnt(0)
  v_add_f32 v0, v0, v1
  global_atomic_add_f32 v242, v0, s[32:33] offset:0
  v_add_f32 v2, v2, v3
  global_atomic_add_f32 v242, v2, s[32:33] offset:256
  v_add_f32 v4, v4, v5
  global_atomic_add_f32 v242, v4, s[32:33] offset:512
  v_add_f32 v6, v6, v7
  global_atomic_add_f32 v242, v6, s[32:33] offset:768
  v_add_f32 v8, v8, v9
  s_and_saveexec_b64 s[60:61], vcc
  global_atomic_add_f32 v242, v8, s[32:33] offset:1024
  s_mov_b64 exec, s[60:61]
K12_g2:
  s_mov_b32 s12, s78
  s_and_b32 s13, s79, 0xffff
  s_mov_b32 s14, 2097152
  s_mov_b32 s15, 0x20000
  s_mov_b32 s16, s64
  s_and_b32 s17, s65, 0xffff
  s_mov_b32 s18, 2097152
  s_mov_b32 s19, 0x20000
  s_lshl_b32 s71, s83, 2
  s_add_u32 s71, s71, s34
  s_lshl_b32 s54, s71, 6
  s_add_u32 s54, s54, 69632
  v_lshlrev_b32 v250, 2, v236
  v_add_u32 v250, s54, v250
  s_mul_i32 s71, s71, 73728
  s_add_u32 s58, s71, 57344
  s_mov_b32 s74, s71
  s_lshl_b32 s75, s77, 11
  v_and_b32 v240, 31, v236
  v_lshrrev_b32 v241, 5, v236
  v_lshlrev_b32 v242, 4, v241
  v_add_u32 v242, v242, v240
  v_subrev_u32 v242, 16, v242
  v_lshlrev_b32 v242, 5, v242
  v_lshlrev_b32 v243, 5, v241
  v_add_u32 v243, 1024, v243
  v_cmp_gt_u32 vcc, 16, v240
  s_nop 1
  v_cndmask_b32 v242, v242, v243, vcc
  s_lshl_b32 s54, s34, 3
  s_mul_i32 s54, s54, 1152
  s_add_u32 s54, s54, 32768
  v_add_u32 v251, s54, v242
  s_lshl_b32 s54, s34, 9
  s_add_u32 s54, s54, 77824
  v_lshlrev_b32 v252, 6, v236
  v_add_u32 v252, s54, v252
  s_barrier
  s_mov_b64 exec, 255
  global_load_dword v249, v250, s[32:33] sc1
  s_mov_b64 exec, -1
  s_waitcnt vmcnt(0)
  s_cmp_ge_u32 s82, 2
  s_cbranch_scc1 K12_sigB
  s_lshl_b32 s54, s37, 1
  s_add_u32 s54, s54, s35
  s_lshl_b32 s54, s54, 2
  s_lshr_b32 s55, s38, 1
  s_add_u32 s54, s54, s55
  s_lshl_b32 s54, s54, 4
  s_lshl_b32 s55, s81, 1
  s_add_u32 s54, s54, s55
  s_add_u32 s54, s54, s36
  s_add_u32 s54, s54, 8
  s_lshl_b32 s54, s54, 2
  s_add_u32 s54, s54, 69632
  v_mov_b32 v244, s54
  v_mov_b32 v245, 1
  s_mov_b64 s[60:61], exec
  s_mov_b64 exec, 1
  global_store_dword v244, v245, s[32:33] sc1
  s_mov_b64 exec, s[60:61]
  s_branch K12_sigX
K12_sigB:
  s_lshl_b32 s54, s38, 2
  s_add_u32 s54, s54, s34
  s_lshl_b32 s54, s54, 6
  s_add_u32 s54, s54, 77824
  v_mov_b32 v244, s54
  v_mov_b32 v245, 1
  s_mov_b64 s[60:61], exec
  s_mov_b64 exec, 1
  global_atomic_add v244, v245, s[32:33] sc1
  s_mov_b64 exec, s[60:61]
K12_sigX:
  s_mov_b64 exec, 255
  v_cmp_ne_u32 vcc, 0, v249
  s_nop 3
  s_cmp_eq_u64 vcc, exec
  s_mov_b64 exec, -1
  s_cbranch_scc1 K12_hok
  s_mov_b32 s57, 0
  s_mov_b64 s[60:61], exec
  s_mov_b64 exec, 255
K12_pollH:
  global_load_dword v249, v250, s[32:33] sc1
  s_waitcnt vmcnt(0)
  v_cmp_ne_u32 vcc, 0, v249
  s_add_u32 s57, s57, 1
  s_cmp_ge_u32 s57, 200000
  s_cbranch_scc1 K12_pollH_x
  s_cmp_eq_u64 vcc, exec
  s_cbranch_scc1 K12_pollH_x
  s_sleep 1
  s_branch K12_pollH
K12_pollH_x:
  s_mov_b64 exec, s[60:61]
K12_hok:
  s_mul_i32 s54, s70, 7168
  s_add_u32 s54, s54, s71
  s_add_u32 s71, s74, s75
  buffer_load_dwordx4 v[64:67], v237, s[28:31], s71 offen offset:0 sc1
  buffer_load_dwordx4 v[68:71], v237, s[28:31], s71 offen offset:1024 sc1
  s_add_u32 s75, s75, 2048
  s_cmp_eq_u32 s75, 57344
  s_cselect_b32 s75, 0, s75
  s_add_u32 s71, s74, s75
  buffer_load_dwordx4 v[72:75], v237, s[28:31], s71 offen offset:0 sc1
  buffer_load_dwordx4 v[76:79], v237, s[28:31], s71 offen offset:1024 sc1
  s_add_u32 s75, s75, 2048
  s_cmp_eq_u32 s75, 57344
  s_cselect_b32 s75, 0, s75
  s_add_u32 s71, s74, s75
  buffer_load_dwordx4 v[80:83], v237, s[28:31], s71 offen offset:0 sc1
  buffer_load_dwordx4 v[84:87], v237, s[28:31], s71 offen offset:1024 sc1
  s_add_u32 s75, s75, 2048
  s_cmp_eq_u32 s75, 57344
  s_cselect_b32 s75, 0, s75
  s_add_u32 s71, s74, s75
  buffer_load_dwordx4 v[88:91], v237, s[28:31], s71 offen offset:0 sc1
  buffer_load_dwordx4 v[92:95], v237, s[28:31], s71 offen offset:1024 sc1
  s_add_u32 s75, s75, 2048
  s_cmp_eq_u32 s75, 57344
  s_cselect_b32 s75, 0, s75
  s_add_u32 s71, s74, s75
  buffer_load_dwordx4 v[96:99], v237, s[28:31], s71 offen offset:0 sc1
  buffer_load_dwordx4 v[100:103], v237, s[28:31], s71 offen offset:1024 sc1
  s_add_u32 s75, s75, 2048
  s_cmp_eq_u32 s75, 57344
  s_cselect_b32 s75, 0, s75
  s_add_u32 s71, s74, s75
  buffer_load_dwordx4 v[104:107], v237, s[28:31], s71 offen offset:0 sc1
  buffer_load_dwordx4 v[108:111], v237, s[28:31], s71 offen offset:1024 sc1
  s_add_u32 s75, s75, 2048
  s_cmp_eq_u32 s75, 57344
  s_cselect_b32 s75, 0, s75
  s_add_u32 s71, s74, s75
  buffer_load_dwordx4 v[112:115], v237, s[28:31], s71 offen offset:0 sc1
  buffer_load_dwordx4 v[116:119], v237, s[28:31], s71 offen offset:1024 sc1
  s_add_u32 s75, s75, 2048
  s_cmp_eq_u32 s75, 57344
  s_cselect_b32 s75, 0, s75
  s_waitcnt vmcnt(12)
  v_mfma_f32_32x32x16_bf16 v[0:15], a[0:3], v[64:67], 0
  v_mfma_f32_32x32x16_bf16 v[32:47], a[4:7], v[64:67], 0
  s_add_u32 s71, s74, s75
  buffer_load_dwordx4 v[120:123], v237, s[28:31], s71 offen offset:0 sc1
  v_mfma_f32_32x32x16_bf16 v[16:31], a[0:3], v[68:71], 0
  buffer_load_dwordx4 v[124:127], v237, s[28:31], s71 offen offset:1024 sc1
  s_add_u32 s75, s75, 2048
  s_cmp_eq_u32 s75, 57344
  s_cselect_b32 s75, 0, s75
  v_mfma_f32_32x32x16_bf16 v[48:63], a[4:7], v[68:71], 0
  s_waitcnt vmcnt(12)
  v_mfma_f32_32x32x16_bf16 v[0:15], a[8:11], v[72:75], v[0:15]
  v_mfma_f32_32x32x16_bf16 v[32:47], a[12:15], v[72:75], v[32:47]
  s_add_u32 s71, s74, s75
  buffer_load_dwordx4 v[64:67], v237, s[28:31], s71 offen offset:0 sc1
  v_mfma_f32_32x32x16_bf16 v[16:31], a[8:11], v[76:79], v[16:31]
  buffer_load_dwordx4 v[68:71], v237, s[28:31], s71 offen offset:1024 sc1
  s_add_u32 s75, s75, 2048
  s_cmp_eq_u32 s75, 57344
  s_cselect_b32 s75, 0, s75
  v_mfma_f32_32x32x16_bf16 v[48:63], a[12:15], v[76:79], v[48:63]
  s_waitcnt vmcnt(12)
  v_mfma_f32_32x32x16_bf16 v[0:15], a[16:19], v[80:83], v[0:15]
  ds_read_b64_tr_b16 a[224:225], v254 offset:0
  ds_read_b64_tr_b16 a[226:227], v254 offset:1024
  v_mfma_f32_32x32x16_bf16 v[32:47], a[20:23], v[80:83], v[32:47]
  s_add_u32 s71, s74, s75
  buffer_load_dwordx4 v[72:75], v237, s[28:31], s71 offen offset:0 sc1
  v_mfma_f32_32x32x16_bf16 v[16:31], a[16:19], v[84:87], v[16:31]
  buffer_load_dwordx4 v[76:79], v237, s[28:31], s71 offen offset:1024 sc1
  s_add_u32 s75, s75, 2048
  s_cmp_eq_u32 s75, 57344
  s_cselect_b32 s75, 0, s75
  v_mfma_f32_32x32x16_bf16 v[48:63], a[20:23], v[84:87], v[48:63]
  ds_read_b64_tr_b16 a[228:229], v255 offset:0
  ds_read_b64_tr_b16 a[230:231], v255 offset:1024
  s_waitcnt vmcnt(12)
  v_mfma_f32_32x32x16_bf16 v[0:15], a[24:27], v[88:91], v[0:15]
  ds_read_b64_tr_b16 a[232:233], v254 offset:2048
  ds_read_b64_tr_b16 a[234:235], v254 offset:3072
  v_mfma_f32_32x32x16_bf16 v[32:47], a[28:31], v[88:91], v[32:47]
  s_add_u32 s71, s74, s75
  buffer_load_dwordx4 v[80:83], v237, s[28:31], s71 offen offset:0 sc1
  v_mfma_f32_32x32x16_bf16 v[16:31], a[24:27], v[92:95], v[16:31]
  buffer_load_dwordx4 v[84:87], v237, s[28:31], s71 offen offset:1024 sc1
  s_add_u32 s75, s75, 2048
  s_cmp_eq_u32 s75, 57344
  s_cselect_b32 s75, 0, s75
  v_mfma_f32_32x32x16_bf16 v[48:63], a[28:31], v[92:95], v[48:63]
  ds_read_b64_tr_b16 a[236:237], v255 offset:2048
  ds_read_b64_tr_b16 a[238:239], v255 offset:3072
  s_waitcnt vmcnt(12)
  v_mfma_f32_32x32x16_bf16 v[0:15], a[32:35], v[96:99], v[0:15]
  ds_read_b64_tr_b16 a[240:241], v254 offset:4096
  ds_read_b64_tr_b16 a[242:243], v254 offset:5120
  v_mfma_f32_32x32x16_bf16 v[32:47], a[36:39], v[96:99], v[32:47]
  s_add_u32 s71, s74, s75
  buffer_load_dwordx4 v[88:91], v237, s[28:31], s71 offen offset:0 sc1
  v_mfma_f32_32x32x16_bf16 v[16:31], a[32:35], v[100:103], v[16:31]
  buffer_load_dwordx4 v[92:95], v237, s[28:31], s71 offen offset:1024 sc1
  s_add_u32 s75, s75, 2048
  s_cmp_eq_u32 s75, 57344
  s_cselect_b32 s75, 0, s75
  v_mfma_f32_32x32x16_bf16 v[48:63], a[36:39], v[100:103], v[48:63]
  ds_read_b64_tr_b16 a[244:245], v255 offset:4096
  ds_read_b64_tr_b16 a[246:247], v255 offset:5120
  s_waitcnt vmcnt(12)
  v_mfma_f32_32x32x16_bf16 v[0:15], a[40:43], v[104:107], v[0:15]
  ds_read_b64_tr_b16 a[248:249], v254 offset:6144
  ds_read_b64_tr_b16 a[250:251], v254 offset:7168
  v_mfma_f32_32x32x16_bf16 v[32:47], a[44:47], v[104:107], v[32:47]
  s_add_u32 s71, s74, s75
  buffer_load_dwordx4 v[96:99], v237, s[28:31], s71 offen offset:0 sc1
  v_mfma_f32_32x32x16_bf16 v[16:31], a[40:43], v[108:111], v[16:31]
  buffer_load_dwordx4 v[100:103], v237, s[28:31], s71 offen offset:1024 sc1
  s_add_u32 s75, s75, 2048
  s_cmp_eq_u32 s75, 57344
  s_cselect_b32 s75, 0, s75
  v_mfma_f32_32x32x16_bf16 v[48:63], a[44:47], v[108:111], v[48:63]
  ds_read_b64_tr_b16 a[252:253], v255 offset:6144
  ds_read_b64_tr_b16 a[254:255], v255 offset:7168
  s_waitcnt vmcnt(12)
  v_mfma_f32_32x32x16_bf16 v[0:15], a[48:51], v[112:115], v[0:15]
  ds_read_b64_tr_b16 v[192:193], v254 offset:8192
  ds_read_b64_tr_b16 v[194:195], v254 offset:9216
  v_mfma_f32_32x32x16_bf16 v[32:47], a[52:55], v[112:115], v[32:47]
  s_add_u32 s71, s74, s75
  buffer_load_dwordx4 v[104:107], v237, s[28:31], s71 offen offset:0 sc1
  v_mfma_f32_32x32x16_bf16 v[16:31], a[48:51], v[116:119], v[16:31]
  buffer_load_dwordx4 v[108:111], v237, s[28:31], s71 offen offset:1024 sc1
  s_add_u32 s75, s75, 2048
  s_cmp_eq_u32 s75, 57344
  s_cselect_b32 s75, 0, s75
  v_mfma_f32_32x32x16_bf16 v[48:63], a[52:55], v[116:119], v[48:63]
  ds_read_b64_tr_b16 v[196:197], v255 offset:8192
  ds_read_b64_tr_b16 v[198:199], v255 offset:9216
  s_waitcnt vmcnt(12)
  v_mfma_f32_32x32x16_bf16 v[0:15], a[56:59], v[120:123], v[0:15]
  ds_read_b64_tr_b16 v[200:201], v254 offset:10240
  ds_read_b64_tr_b16 v[202:203], v254 offset:11264
  v_mfma_f32_32x32x16_bf16 v[32:47], a[60:63], v[120:123], v[32:47]
  s_add_u32 s71, s74, s75
  buffer_load_dwordx4 v[112:115], v237, s[28:31], s71 offen offset:0 sc1
  v_mfma_f32_32x32x16_bf16 v[16:31], a[56:59], v[124:127], v[16:31]
  buffer_load_dwordx4 v[116:119], v237, s[28:31], s71 offen offset:1024 sc1
  s_add_u32 s75, s75, 2048
  s_cmp_eq_u32 s75, 57344
  s_cselect_b32 s75, 0, s75
  v_mfma_f32_32x32x16_bf16 v[48:63], a[60:63], v[124:127], v[48:63]
  ds_read_b64_tr_b16 v[204:205], v255 offset:10240
  ds_read_b64_tr_b16 v[206:207], v255 offset:11264
  s_waitcnt vmcnt(12)
  v_mfma_f32_32x32x16_bf16 v[0:15], a[64:67], v[64:67], v[0:15]
  ds_read_b64_tr_b16 v[208:209], v254 offset:12288
  ds_read_b64_tr_b16 v[210:211], v254 offset:13312
  v_mfma_f32_32x32x16_bf16 v[32:47], a[68:71], v[64:67], v[32:47]
  s_add_u32 s71, s74, s75
  buffer_load_dwordx4 v[120:123], v237, s[28:31], s71 offen offset:0 sc1
  v_mfma_f32_32x32x16_bf16 v[16:31], a[64:67], v[68:71], v[16:31]
  buffer_load_dwordx4 v[124:127], v237, s[28:31], s71 offen offset:1024 sc1
  s_add_u32 s75, s75, 2048
  s_cmp_eq_u32 s75, 57344
  s_cselect_b32 s75, 0, s75
  v_mfma_f32_32x32x16_bf16 v[48:63], a[68:71], v[68:71], v[48:63]
  ds_read_b64_tr_b16 v[212:213], v255 offset:12288
  ds_read_b64_tr_b16 v[214:215], v255 offset:13312
  s_waitcnt vmcnt(12)
  v_mfma_f32_32x32x16_bf16 v[0:15], a[72:75], v[72:75], v[0:15]
  ds_read_b64_tr_b16 v[216:217], v254 offset:14336
  ds_read_b64_tr_b16 v[218:219], v254 offset:15360
  v_mfma_f32_32x32x16_bf16 v[32:47], a[76:79], v[72:75], v[32:47]
  s_add_u32 s71, s74, s75
  buffer_load_dwordx4 v[64:67], v237, s[28:31], s71 offen offset:0 sc1
  v_mfma_f32_32x32x16_bf16 v[16:31], a[72:75], v[76:79], v[16:31]
  buffer_load_dwordx4 v[68:71], v237, s[28:31], s71 offen offset:1024 sc1
  s_add_u32 s75, s75, 2048
  s_cmp_eq_u32 s75, 57344
  s_cselect_b32 s75, 0, s75
  v_mfma_f32_32x32x16_bf16 v[48:63], a[76:79], v[76:79], v[48:63]
  ds_read_b64_tr_b16 v[220:221], v255 offset:14336
  ds_read_b64_tr_b16 v[222:223], v255 offset:15360
  s_waitcnt vmcnt(12)
  v_mfma_f32_32x32x16_bf16 v[0:15], a[80:83], v[80:83], v[0:15]
  v_mfma_f32_32x32x16_bf16 v[32:47], a[84:87], v[80:83], v[32:47]
  s_add_u32 s71, s74, s75
  buffer_load_dwordx4 v[72:75], v237, s[28:31], s71 offen offset:0 sc1
  v_mfma_f32_32x32x16_bf16 v[16:31], a[80:83], v[84:87], v[16:31]
  buffer_load_dwordx4 v[76:79], v237, s[28:31], s71 offen offset:1024 sc1
  s_add_u32 s75, s75, 2048
  s_cmp_eq_u32 s75, 57344
  s_cselect_b32 s75, 0, s75
  v_mfma_f32_32x32x16_bf16 v[48:63], a[84:87], v[84:87], v[48:63]
  s_waitcnt vmcnt(12)
  v_mfma_f32_32x32x16_bf16 v[0:15], a[88:91], v[88:91], v[0:15]
  v_mfma_f32_32x32x16_bf16 v[32:47], a[92:95], v[88:91], v[32:47]
  s_add_u32 s71, s74, s75
  buffer_load_dwordx4 v[80:83], v237, s[28:31], s71 offen offset:0 sc1
  v_mfma_f32_32x32x16_bf16 v[16:31], a[88:91], v[92:95], v[16:31]
  buffer_load_dwordx4 v[84:87], v237, s[28:31], s71 offen offset:1024 sc1
  s_add_u32 s75, s75, 2048
  s_cmp_eq_u32 s75, 57344
  s_cselect_b32 s75, 0, s75
  v_mfma_f32_32x32x16_bf16 v[48:63], a[92:95], v[92:95], v[48:63]
  s_waitcnt vmcnt(12)
  v_mfma_f32_32x32x16_bf16 v[0:15], a[96:99], v[96:99], v[0:15]
  v_mfma_f32_32x32x16_bf16 v[32:47], a[100:103], v[96:99], v[32:47]
  s_add_u32 s71, s74, s75
  buffer_load_dwordx4 v[88:91], v237, s[28:31], s71 offen offset:0 sc1
  v_mfma_f32_32x32x16_bf16 v[16:31], a[96:99], v[100:103], v[16:31]
  buffer_load_dwordx4 v[92:95], v237, s[28:31], s71 offen offset:1024 sc1
  s_add_u32 s75, s75, 2048
  s_cmp_eq_u32 s75, 57344
  s_cselect_b32 s75, 0, s75
  v_mfma_f32_32x32x16_bf16 v[48:63], a[100:103], v[100:103], v[48:63]
  s_waitcnt vmcnt(12)
  v_mfma_f32_32x32x16_bf16 v[0:15], a[104:107], v[104:107], v[0:15]
  v_mfma_f32_32x32x16_bf16 v[32:47], a[108:111], v[104:107], v[32:47]
  s_add_u32 s71, s74, s75
  buffer_load_dwordx4 v[96:99], v237, s[28:31], s71 offen offset:0 sc1
  v_mfma_f32_32x32x16_bf16 v[16:31], a[104:107], v[108:111], v[16:31]
  buffer_load_dwordx4 v[100:103], v237, s[28:31], s71 offen offset:1024 sc1
  s_add_u32 s75, s75, 2048
  s_cmp_eq_u32 s75, 57344
  s_cselect_b32 s75, 0, s75
  v_mfma_f32_32x32x16_bf16 v[48:63], a[108:111], v[108:111], v[48:63]
  s_waitcnt vmcnt(12)
  v_mfma_f32_32x32x16_bf16 v[0:15], a[112:115], v[112:115], v[0:15]
  v_mfma_f32_32x32x16_bf16 v[32:47], a[116:119], v[112:115], v[32:47]
  s_add_u32 s71, s74, s75
  buffer_load_dwordx4 v[104:107], v237, s[28:31], s71 offen offset:0 sc1
  v_mfma_f32_32x32x16_bf16 v[16:31], a[112:115], v[116:119], v[16:31]
  buffer_load_dwordx4 v[108:111], v237, s[28:31], s71 offen offset:1024 sc1
  s_add_u32 s75, s75, 2048
  s_cmp_eq_u32 s75, 57344
  s_cselect_b32 s75, 0, s75
  v_mfma_f32_32x32x16_bf16 v[48:63], a[116:119], v[116:119], v[48:63]
  s_waitcnt vmcnt(12)
  v_mfma_f32_32x32x16_bf16 v[0:15], a[120:123], v[120:123], v[0:15]
  v_mfma_f32_32x32x16_bf16 v[32:47], a[124:127], v[120:123], v[32:47]
  s_add_u32 s71, s74, s75
  buffer_load_dwordx4 v[112:115], v237, s[28:31], s71 offen offset:0 sc1
  v_mfma_f32_32x32x16_bf16 v[16:31], a[120:123], v[124:127], v[16:31]
  buffer_load_dwordx4 v[116:119], v237, s[28:31], s71 offen offset:1024 sc1
  s_add_u32 s75, s75, 2048
  s_cmp_eq_u32 s75, 57344
  s_cselect_b32 s75, 0, s75
  v_mfma_f32_32x32x16_bf16 v[48:63], a[124:127], v[124:127], v[48:63]
  s_waitcnt vmcnt(12)
  v_mfma_f32_32x32x16_bf16 v[0:15], a[128:131], v[64:67], v[0:15]
  v_mfma_f32_32x32x16_bf16 v[32:47], a[132:135], v[64:67], v[32:47]
  s_add_u32 s71, s74, s75
  buffer_load_dwordx4 v[120:123], v237, s[28:31], s71 offen offset:0 sc1
  v_mfma_f32_32x32x16_bf16 v[16:31], a[128:131], v[68:71], v[16:31]
  buffer_load_dwordx4 v[124:127], v237, s[28:31], s71 offen offset:1024 sc1
  s_add_u32 s75, s75, 2048
  s_cmp_eq_u32 s75, 57344
  s_cselect_b32 s75, 0, s75
  v_mfma_f32_32x32x16_bf16 v[48:63], a[132:135], v[68:71], v[48:63]
  s_waitcnt vmcnt(12)
  v_mfma_f32_32x32x16_bf16 v[0:15], a[136:139], v[72:75], v[0:15]
  v_add_u32 v250, 32, v250
  s_mov_b64 s[60:61], exec
  s_mov_b64 exec, 15
  global_load_dword v248, v250, s[32:33] sc1
  s_mov_b64 exec, 255
  global_load_dword v249, v252, s[32:33] sc1
  s_mov_b64 exec, s[60:61]
  v_mfma_f32_32x32x16_bf16 v[32:47], a[140:143], v[72:75], v[32:47]
  s_add_u32 s71, s74, s75
  buffer_load_dwordx4 v[64:67], v237, s[28:31], s71 offen offset:0 sc1
  v_mfma_f32_32x32x16_bf16 v[16:31], a[136:139], v[76:79], v[16:31]
  buffer_load_dwordx4 v[68:71], v237, s[28:31], s71 offen offset:1024 sc1
  s_add_u32 s75, s75, 2048
  s_cmp_eq_u32 s75, 57344
  s_cselect_b32 s75, 0, s75
  v_mfma_f32_32x32x16_bf16 v[48:63], a[140:143], v[76:79], v[48:63]
  s_waitcnt vmcnt(14)
  v_mfma_f32_32x32x16_bf16 v[0:15], a[144:147], v[80:83], v[0:15]
  v_mfma_f32_32x32x16_bf16 v[32:47], a[148:151], v[80:83], v[32:47]
  s_add_u32 s71, s74, s75
  buffer_load_dwordx4 v[72:75], v237, s[28:31], s71 offen offset:0 sc1
  v_mfma_f32_32x32x16_bf16 v[16:31], a[144:147], v[84:87], v[16:31]
  buffer_load_dwordx4 v[76:79], v237, s[28:31], s71 offen offset:1024 sc1
  s_add_u32 s75, s75, 2048
  s_cmp_eq_u32 s75, 57344
  s_cselect_b32 s75, 0, s75
  v_mfma_f32_32x32x16_bf16 v[48:63], a[148:151], v[84:87], v[48:63]
  s_waitcnt vmcnt(14)
  v_mfma_f32_32x32x16_bf16 v[0:15], a[152:155], v[88:91], v[0:15]
  v_mfma_f32_32x32x16_bf16 v[32:47], a[156:159], v[88:91], v[32:47]
  s_add_u32 s71, s74, s75
  buffer_load_dwordx4 v[80:83], v237, s[28:31], s71 offen offset:0 sc1
  v_mfma_f32_32x32x16_bf16 v[16:31], a[152:155], v[92:95], v[16:31]
  buffer_load_dwordx4 v[84:87], v237, s[28:31], s71 offen offset:1024 sc1
  s_add_u32 s75, s75, 2048
  s_cmp_eq_u32 s75, 57344
  s_cselect_b32 s75, 0, s75
  v_mfma_f32_32x32x16_bf16 v[48:63], a[156:159], v[92:95], v[48:63]
  s_waitcnt vmcnt(14)
  v_mfma_f32_32x32x16_bf16 v[0:15], a[160:163], v[96:99], v[0:15]
  v_mfma_f32_32x32x16_bf16 v[32:47], a[164:167], v[96:99], v[32:47]
  s_add_u32 s71, s74, s75
  buffer_load_dwordx4 v[88:91], v237, s[28:31], s71 offen offset:0 sc1
  v_mfma_f32_32x32x16_bf16 v[16:31], a[160:163], v[100:103], v[16:31]
  buffer_load_dwordx4 v[92:95], v237, s[28:31], s71 offen offset:1024 sc1
  v_mfma_f32_32x32x16_bf16 v[48:63], a[164:167], v[100:103], v[48:63]
  s_waitcnt vmcnt(14)
  v_mfma_f32_32x32x16_bf16 v[0:15], a[168:171], v[104:107], v[0:15]
  v_mfma_f32_32x32x16_bf16 v[32:47], a[172:175], v[104:107], v[32:47]
  v_mfma_f32_32x32x16_bf16 v[16:31], a[168:171], v[108:111], v[16:31]
  v_mfma_f32_32x32x16_bf16 v[48:63], a[172:175], v[108:111], v[48:63]
  s_waitcnt vmcnt(8)
  s_mov_b64 s[60:61], exec
  s_mov_b64 exec, 15
  v_cmp_ne_u32 vcc, 0, v248
  s_nop 3
  s_cmp_eq_u64 vcc, exec
  s_mov_b64 exec, s[60:61]
  s_cbranch_scc1 K12_qok
  s_mov_b32 s57, 0
  s_mov_b64 s[60:61], exec
  s_mov_b64 exec, 15
K12_pollQ:
  global_load_dword v249, v250, s[32:33] sc1
  s_waitcnt vmcnt(0)
  v_cmp_ne_u32 vcc, 0, v249
  s_add_u32 s57, s57, 1
  s_cmp_ge_u32 s57, 200000
  s_cbranch_scc1 K12_pollQ_x
  s_cmp_eq_u64 vcc, exec
  s_cbranch_scc1 K12_pollQ_x
  s_sleep 1
  s_branch K12_pollQ
K12_pollQ_x:
  s_mov_b64 exec, s[60:61]
K12_qok:
  s_mov_b64 s[60:61], exec
  s_mov_b64 exec, 255
  v_cmp_le_u32 vcc, 16, v249
  s_nop 3
  s_cmp_eq_u64 vcc, exec
  s_mov_b64 exec, s[60:61]
  s_cbranch_scc1 K12_kvok
  s_mov_b32 s57, 0
  s_mov_b64 s[60:61], exec
  s_mov_b64 exec, 255
K12_pollKV:
  global_load_dword v249, v252, s[32:33] sc1
  s_waitcnt vmcnt(0)
  v_cmp_le_u32 vcc, 16, v249
  s_add_u32 s57, s57, 1
  s_cmp_ge_u32 s57, 200000
  s_cbranch_scc1 K12_pollKV_x
  s_cmp_eq_u64 vcc, exec
  s_cbranch_scc1 K12_pollKV_x
  s_sleep 1
  s_branch K12_pollKV
K12_pollKV_x:
  s_mov_b64 exec, s[60:61]
K12_kvok:
  s_waitcnt vmcnt(12)
  v_mfma_f32_32x32x16_bf16 v[0:15], a[176:179], v[112:115], v[0:15]
  v_mfma_f32_32x32x16_bf16 v[32:47], a[180:183], v[112:115], v[32:47]
  global_load_dwordx4 v[128:131], v251, s[32:33] sc1
  global_load_dwordx4 v[132:135], v251, s[32:33] offset:16 sc1
  v_add_u32 v251, 1152, v251
  v_mfma_f32_32x32x16_bf16 v[16:31], a[176:179], v[116:119], v[16:31]
  s_add_u32 s71, s58, 0
  buffer_load_dwordx4 a[0:3], v237, s[28:31], s71 offen offset:0 sc1
  v_mfma_f32_32x32x16_bf16 v[48:63], a[180:183], v[116:119], v[48:63]
  s_waitcnt vmcnt(13)
  v_mfma_f32_32x32x16_bf16 v[0:15], a[184:187], v[120:123], v[0:15]
  v_mfma_f32_32x32x16_bf16 v[32:47], a[188:191], v[120:123], v[32:47]
  global_load_dwordx4 v[136:139], v251, s[32:33] sc1
  global_load_dwordx4 v[140:143], v251, s[32:33] offset:16 sc1
  v_add_u32 v251, 1152, v251
  v_mfma_f32_32x32x16_bf16 v[16:31], a[184:187], v[124:127], v[16:31]
  s_add_u32 s71, s58, 0
  buffer_load_dwordx4 a[8:11], v237, s[28:31], s71 offen offset:2048 sc1
  v_mfma_f32_32x32x16_bf16 v[48:63], a[188:191], v[124:127], v[48:63]
  s_waitcnt vmcnt(12)
  v_mfma_f32_32x32x16_bf16 v[0:15], a[192:195], v[64:67], v[0:15]
  v_mfma_f32_32x32x16_bf16 v[32:47], a[196:199], v[64:67], v[32:47]
  global_load_dwordx4 v[144:147], v251, s[32:33] sc1
  global_load_dwordx4 v[148:151], v251, s[32:33] offset:16 sc1
  v_add_u32 v251, 1152, v251
  v_mfma_f32_32x32x16_bf16 v[16:31], a[192:195], v[68:71], v[16:31]
  s_add_u32 s71, s58, 4096
  buffer_load_dwordx4 a[16:19], v237, s[28:31], s71 offen offset:0 sc1
  v_mfma_f32_32x32x16_bf16 v[48:63], a[196:199], v[68:71], v[48:63]
  s_waitcnt vmcnt(13)
  v_mfma_f32_32x32x16_bf16 v[0:15], a[200:203], v[72:75], v[0:15]
  v_mfma_f32_32x32x16_bf16 v[32:47], a[204:207], v[72:75], v[32:47]
  global_load_dwordx4 v[152:155], v251, s[32:33] sc1
  global_load_dwordx4 v[156:159], v251, s[32:33] offset:16 sc1
  v_add_u32 v251, 1152, v251
  v_mfma_f32_32x32x16_bf16 v[16:31], a[200:203], v[76:79], v[16:31]
  s_add_u32 s71, s58, 4096
  buffer_load_dwordx4 a[24:27], v237, s[28:31], s71 offen offset:2048 sc1
  v_mfma_f32_32x32x16_bf16 v[48:63], a[204:207], v[76:79], v[48:63]
  s_waitcnt vmcnt(14)
  v_mfma_f32_32x32x16_bf16 v[0:15], a[208:211], v[80:83], v[0:15]
  v_mfma_f32_32x32x16_bf16 v[32:47], a[212:215], v[80:83], v[32:47]
  global_load_dwordx4 v[160:163], v251, s[32:33] sc1
  global_load_dwordx4 v[164:167], v251, s[32:33] offset:16 sc1
  v_add_u32 v251, 1152, v251
  v_mfma_f32_32x32x16_bf16 v[16:31], a[208:211], v[84:87], v[16:31]
  s_add_u32 s71, s58, 8192
  buffer_load_dwordx4 a[32:35], v237, s[28:31], s71 offen offset:0 sc1
  v_mfma_f32_32x32x16_bf16 v[48:63], a[212:215], v[84:87], v[48:63]
  s_waitcnt vmcnt(15)
  v_mfma_f32_32x32x16_bf16 v[0:15], a[216:219], v[88:91], v[0:15]
  v_mfma_f32_32x32x16_bf16 v[32:47], a[220:223], v[88:91], v[32:47]
  global_load_dwordx4 v[168:171], v251, s[32:33] sc1
  global_load_dwordx4 v[172:175], v251, s[32:33] offset:16 sc1
  v_add_u32 v251, 1152, v251
  v_mfma_f32_32x32x16_bf16 v[16:31], a[216:219], v[92:95], v[16:31]
  s_add_u32 s71, s58, 8192
  buffer_load_dwordx4 a[40:43], v237, s[28:31], s71 offen offset:2048 sc1
  v_mfma_f32_32x32x16_bf16 v[48:63], a[220:223], v[92:95], v[48:63]
  v_lshrrev_b32 v248, 3, v238
  v_and_b32 v249, 7, v238
  s_lshl_b32 s54, s83, 16
  s_lshl_b32 s56, s70, 7
  s_add_u32 s54, s54, s56
  v_lshlrev_b32 v250, 10, v248
  v_lshlrev_b32 v252, 4, v249
  v_add_u32 v250, v250, v252
  s_add_u32 s56, s54, 32768
  s_mov_b32 s55, 0x358637bd
  s_waitcnt lgkmcnt(0)
  v_and_b32 v252, 31, v236
  v_mul_u32_u24 v252, 272, v252
  v_lshrrev_b32 v249, 5, v236
  v_lshlrev_b32 v249, 4, v249
  v_add_u32 v252, v252, v249
  s_mul_i32 s57, s34, 17408
  v_add_u32 v252, s57, v252
  s_waitcnt vmcnt(15)
  v_cvt_pk_bf16_f32 v128, v128, v129
  v_cvt_pk_bf16_f32 v129, v130, v131
  v_cvt_pk_bf16_f32 v130, v132, v133
  v_cvt_pk_bf16_f32 v131, v134, v135
  s_nop 1
  v_mfma_f32_32x32x16_bf16 v[96:111], v[128:131], a[0:3], 0
  global_load_dwordx4 v[176:179], v251, s[32:33] sc1
  global_load_dwordx4 v[180:183], v251, s[32:33] offset:16 sc1
  v_add_u32 v251, 1152, v251
  s_waitcnt vmcnt(14)
  v_cvt_pk_bf16_f32 v136, v136, v137
  v_cvt_pk_bf16_f32 v137, v138, v139
  v_cvt_pk_bf16_f32 v138, v140, v141
  v_cvt_pk_bf16_f32 v139, v142, v143
  s_nop 1
  v_mfma_f32_32x32x16_bf16 v[112:127], v[136:139], a[8:11], 0
  s_add_u32 s71, s58, 12288
  buffer_load_dwordx4 a[48:51], v237, s[28:31], s71 offen offset:0 sc1
  global_load_dwordx4 v[184:187], v251, s[32:33] sc1
  global_load_dwordx4 v[188:191], v251, s[32:33] offset:16 sc1
  v_add_u32 v251, 1152, v251
  s_nop 7
  s_nop 3
  v_add_f32 v248, s55, v96
  v_rcp_f32 v248, v248
  s_nop 0
  v_mul_f32 v104, v248, v104
  v_mul_f32 v105, v248, v105
  v_mul_f32 v106, v248, v106
  v_mul_f32 v107, v248, v107
  v_mul_f32 v108, v248, v108
  v_mul_f32 v109, v248, v109
  v_mul_f32 v110, v248, v110
  v_mul_f32 v111, v248, v111
  v_cvt_pk_bf16_f32 v240, v104, v105
  v_cvt_pk_bf16_f32 v241, v106, v107
  v_cvt_pk_bf16_f32 v242, v108, v109
  v_cvt_pk_bf16_f32 v243, v110, v111
  s_nop 1
  v_mfma_f32_32x32x16_bf16 v[0:15], a[224:227], v[240:243], v[0:15]
  v_add_f32 v248, s55, v112
  v_rcp_f32 v248, v248
  s_nop 0
  v_mul_f32 v120, v248, v120
  v_mul_f32 v121, v248, v121
  s_waitcnt vmcnt(14)
  v_cvt_pk_bf16_f32 v144, v144, v145
  v_cvt_pk_bf16_f32 v145, v146, v147
  v_cvt_pk_bf16_f32 v146, v148, v149
  v_cvt_pk_bf16_f32 v147, v150, v151
  s_nop 1
  v_mfma_f32_32x32x16_bf16 v[96:111], v[144:147], a[16:19], 0
  s_add_u32 s71, s58, 12288
  buffer_load_dwordx4 a[56:59], v237, s[28:31], s71 offen offset:2048 sc1
  s_add_u32 s71, s58, 0
  buffer_load_dwordx4 a[4:7], v237, s[28:31], s71 offen offset:1024 sc1
  v_mul_f32 v122, v248, v122
  v_mul_f32 v123, v248, v123
  v_mul_f32 v124, v248, v124
  v_mul_f32 v125, v248, v125
  v_mul_f32 v126, v248, v126
  v_mfma_f32_32x32x16_bf16 v[32:47], a[228:231], v[240:243], v[32:47]
  v_mul_f32 v127, v248, v127
  v_cvt_pk_bf16_f32 v244, v120, v121
  v_cvt_pk_bf16_f32 v245, v122, v123
  v_cvt_pk_bf16_f32 v246, v124, v125
  v_cvt_pk_bf16_f32 v247, v126, v127
  s_nop 1
  v_mfma_f32_32x32x16_bf16 v[0:15], a[232:235], v[244:247], v[0:15]
  v_add_f32 v248, s55, v96
  v_rcp_f32 v248, v248
  s_nop 0
  v_mul_f32 v104, v248, v104
  v_mul_f32 v105, v248, v105
  s_waitcnt vmcnt(13)
  v_cvt_pk_bf16_f32 v152, v152, v153
  v_cvt_pk_bf16_f32 v153, v154, v155
  v_cvt_pk_bf16_f32 v154, v156, v157
  v_cvt_pk_bf16_f32 v155, v158, v159
  s_nop 1
  v_mfma_f32_32x32x16_bf16 v[112:127], v[152:155], a[24:27], 0
  s_add_u32 s71, s58, 0
  buffer_load_dwordx4 a[12:15], v237, s[28:31], s71 offen offset:3072 sc1
  s_add_u32 s71, s58, 4096
  buffer_load_dwordx4 a[20:23], v237, s[28:31], s71 offen offset:1024 sc1
  v_mul_f32 v106, v248, v106
  v_mul_f32 v107, v248, v107
  v_mul_f32 v108, v248, v108
  v_mul_f32 v109, v248, v109
  v_mul_f32 v110, v248, v110
  v_mfma_f32_32x32x16_bf16 v[32:47], a[236:239], v[244:247], v[32:47]
  v_mul_f32 v111, v248, v111
  v_cvt_pk_bf16_f32 v240, v104, v105
  v_cvt_pk_bf16_f32 v241, v106, v107
  v_cvt_pk_bf16_f32 v242, v108, v109
  v_cvt_pk_bf16_f32 v243, v110, v111
  s_nop 1
  v_mfma_f32_32x32x16_bf16 v[0:15], a[240:243], v[240:243], v[0:15]
  v_add_f32 v248, s55, v112
  v_rcp_f32 v248, v248
  s_nop 0
  v_mul_f32 v120, v248, v120
  v_mul_f32 v121, v248, v121
  s_waitcnt vmcnt(12)
  v_cvt_pk_bf16_f32 v160, v160, v161
  v_cvt_pk_bf16_f32 v161, v162, v163
  v_cvt_pk_bf16_f32 v162, v164, v165
  v_cvt_pk_bf16_f32 v163, v166, v167
  s_nop 1
  v_mfma_f32_32x32x16_bf16 v[96:111], v[160:163], a[32:35], 0
  s_add_u32 s71, s58, 4096
  buffer_load_dwordx4 a[28:31], v237, s[28:31], s71 offen offset:3072 sc1
  s_add_u32 s71, s58, 8192
  buffer_load_dwordx4 a[36:39], v237, s[28:31], s71 offen offset:1024 sc1
  v_mul_f32 v122, v248, v122
  v_mul_f32 v123, v248, v123
  v_mul_f32 v124, v248, v124
  v_mul_f32 v125, v248, v125
  v_mul_f32 v126, v248, v126
  v_mfma_f32_32x32x16_bf16 v[32:47], a[244:247], v[240:243], v[32:47]
  v_mul_f32 v127, v248, v127
  v_cvt_pk_bf16_f32 v244, v120, v121
  v_cvt_pk_bf16_f32 v245, v122, v123
  v_cvt_pk_bf16_f32 v246, v124, v125
  v_cvt_pk_bf16_f32 v247, v126, v127
  s_nop 1
  v_mfma_f32_32x32x16_bf16 v[0:15], a[248:251], v[244:247], v[0:15]
  v_add_f32 v248, s55, v96
  v_rcp_f32 v248, v248
  s_nop 0
  v_mul_f32 v104, v248, v104
  v_mul_f32 v105, v248, v105
  s_waitcnt vmcnt(11)
  v_cvt_pk_bf16_f32 v168, v168, v169
  v_cvt_pk_bf16_f32 v169, v170, v171
  v_cvt_pk_bf16_f32 v170, v172, v173
  v_cvt_pk_bf16_f32 v171, v174, v175
  s_nop 1
  v_mfma_f32_32x32x16_bf16 v[112:127], v[168:171], a[40:43], 0
  s_add_u32 s71, s58, 8192
  buffer_load_dwordx4 a[44:47], v237, s[28:31], s71 offen offset:3072 sc1
  s_add_u32 s71, s58, 12288
  buffer_load_dwordx4 a[52:55], v237, s[28:31], s71 offen offset:1024 sc1
  v_mul_f32 v106, v248, v106
  v_mul_f32 v107, v248, v107
  v_mul_f32 v108, v248, v108
  v_mul_f32 v109, v248, v109
  v_mul_f32 v110, v248, v110
  v_mfma_f32_32x32x16_bf16 v[32:47], a[252:255], v[244:247], v[32:47]
  v_mul_f32 v111, v248, v111
  v_cvt_pk_bf16_f32 v240, v104, v105
  v_cvt_pk_bf16_f32 v241, v106, v107
  v_cvt_pk_bf16_f32 v242, v108, v109
  v_cvt_pk_bf16_f32 v243, v110, v111
  s_nop 1
  v_mfma_f32_32x32x16_bf16 v[0:15], v[192:195], v[240:243], v[0:15]
  v_add_f32 v248, s55, v112
  v_rcp_f32 v248, v248
  s_nop 0
  v_mul_f32 v120, v248, v120
  v_mul_f32 v121, v248, v121
  s_waitcnt vmcnt(10)
  v_cvt_pk_bf16_f32 v176, v176, v177
  v_cvt_pk_bf16_f32 v177, v178, v179
  v_cvt_pk_bf16_f32 v178, v180, v181
  v_cvt_pk_bf16_f32 v179, v182, v183
  s_nop 1
  v_mfma_f32_32x32x16_bf16 v[96:111], v[176:179], a[48:51], 0
  s_add_u32 s71, s58, 12288
  buffer_load_dwordx4 a[60:63], v237, s[28:31], s71 offen offset:3072 sc1
  v_mul_f32 v122, v248, v122
  v_mul_f32 v123, v248, v123
  v_mul_f32 v124, v248, v124
  v_mul_f32 v125, v248, v125
  v_mul_f32 v126, v248, v126
  v_mfma_f32_32x32x16_bf16 v[32:47], v[196:199], v[240:243], v[32:47]
  v_mul_f32 v127, v248, v127
  v_cvt_pk_bf16_f32 v244, v120, v121
  v_cvt_pk_bf16_f32 v245, v122, v123
  v_cvt_pk_bf16_f32 v246, v124, v125
  v_cvt_pk_bf16_f32 v247, v126, v127
  s_nop 1
  v_mfma_f32_32x32x16_bf16 v[0:15], v[200:203], v[244:247], v[0:15]
  v_add_f32 v248, s55, v96
  v_rcp_f32 v248, v248
  s_nop 0
  v_mul_f32 v104, v248, v104
  v_mul_f32 v105, v248, v105
  s_waitcnt vmcnt(8)
  v_cvt_pk_bf16_f32 v184, v184, v185
  v_cvt_pk_bf16_f32 v185, v186, v187
  v_cvt_pk_bf16_f32 v186, v188, v189
  v_cvt_pk_bf16_f32 v187, v190, v191
  s_nop 1
  v_mfma_f32_32x32x16_bf16 v[112:127], v[184:187], a[56:59], 0
  buffer_load_dwordx4 v[64:67], v250, s[16:19], s54 offen
  buffer_load_dwordx4 v[68:71], v250, s[16:19], s56 offen
  v_mul_f32 v106, v248, v106
  v_mul_f32 v107, v248, v107
  v_mul_f32 v108, v248, v108
  v_mul_f32 v109, v248, v109
  v_mul_f32 v110, v248, v110
  v_mfma_f32_32x32x16_bf16 v[32:47], v[204:207], v[244:247], v[32:47]
  v_mul_f32 v111, v248, v111
  v_cvt_pk_bf16_f32 v240, v104, v105
  v_cvt_pk_bf16_f32 v241, v106, v107
  v_cvt_pk_bf16_f32 v242, v108, v109
  v_cvt_pk_bf16_f32 v243, v110, v111
  s_nop 1
  v_mfma_f32_32x32x16_bf16 v[0:15], v[208:211], v[240:243], v[0:15]
  v_add_f32 v248, s55, v112
  v_rcp_f32 v248, v248
  s_nop 0
  v_mul_f32 v120, v248, v120
  v_mul_f32 v121, v248, v121
  s_waitcnt vmcnt(9)
  v_mfma_f32_32x32x16_bf16 v[96:111], v[128:131], a[4:7], 0
  v_mul_f32 v122, v248, v122
  v_mul_f32 v123, v248, v123
  v_mul_f32 v124, v248, v124
  v_mul_f32 v125, v248, v125
  v_mul_f32 v126, v248, v126
  v_mfma_f32_32x32x16_bf16 v[32:47], v[212:215], v[240:243], v[32:47]
  v_mul_f32 v127, v248, v127
  v_cvt_pk_bf16_f32 v244, v120, v121
  v_cvt_pk_bf16_f32 v245, v122, v123
  v_cvt_pk_bf16_f32 v246, v124, v125
  v_cvt_pk_bf16_f32 v247, v126, v127
  s_nop 1
  v_mfma_f32_32x32x16_bf16 v[0:15], v[216:219], v[244:247], v[0:15]
  v_add_f32 v248, s55, v96
  v_rcp_f32 v248, v248
  s_nop 0
  v_mul_f32 v104, v248, v104
  v_mul_f32 v105, v248, v105
  s_waitcnt vmcnt(8)
  v_mfma_f32_32x32x16_bf16 v[112:127], v[136:139], a[12:15], 0
  v_mul_f32 v106, v248, v106
  v_mul_f32 v107, v248, v107
  v_mul_f32 v108, v248, v108
  v_mul_f32 v109, v248, v109
  v_mul_f32 v110, v248, v110
  v_mfma_f32_32x32x16_bf16 v[32:47], v[220:223], v[244:247], v[32:47]
  v_mul_f32 v111, v248, v111
  v_cvt_pk_bf16_f32 v240, v104, v105
  v_cvt_pk_bf16_f32 v241, v106, v107
  v_cvt_pk_bf16_f32 v242, v108, v109
  v_cvt_pk_bf16_f32 v243, v110, v111
  s_nop 1
  v_mfma_f32_32x32x16_bf16 v[16:31], a[224:227], v[240:243], v[16:31]
  v_add_f32 v248, s55, v112
  v_rcp_f32 v248, v248
  s_nop 0
  v_mul_f32 v120, v248, v120
  v_mul_f32 v121, v248, v121
  s_waitcnt vmcnt(7)
  v_mfma_f32_32x32x16_bf16 v[96:111], v[144:147], a[20:23], 0
  v_mul_f32 v122, v248, v122
  v_mul_f32 v123, v248, v123
  v_mul_f32 v124, v248, v124
  v_mul_f32 v125, v248, v125
  v_mul_f32 v126, v248, v126
  v_mfma_f32_32x32x16_bf16 v[48:63], a[228:231], v[240:243], v[48:63]
  v_mul_f32 v127, v248, v127
  v_cvt_pk_bf16_f32 v244, v120, v121
  v_cvt_pk_bf16_f32 v245, v122, v123
  v_cvt_pk_bf16_f32 v246, v124, v125
  v_cvt_pk_bf16_f32 v247, v126, v127
  s_nop 1
  v_mfma_f32_32x32x16_bf16 v[16:31], a[232:235], v[244:247], v[16:31]
  v_add_f32 v248, s55, v96
  v_rcp_f32 v248, v248
  s_nop 0
  v_mul_f32 v104, v248, v104
  v_mul_f32 v105, v248, v105
  s_waitcnt vmcnt(6)
  v_mfma_f32_32x32x16_bf16 v[112:127], v[152:155], a[28:31], 0
  v_mul_f32 v106, v248, v106
  v_mul_f32 v107, v248, v107
  v_mul_f32 v108, v248, v108
  v_mul_f32 v109, v248, v109
  v_mul_f32 v110, v248, v110
  v_mfma_f32_32x32x16_bf16 v[48:63], a[236:239], v[244:247], v[48:63]
  v_mul_f32 v111, v248, v111
  v_cvt_pk_bf16_f32 v240, v104, v105
  v_cvt_pk_bf16_f32 v241, v106, v107
  v_cvt_pk_bf16_f32 v242, v108, v109
  v_cvt_pk_bf16_f32 v243, v110, v111
  ds_write_b128 v252, v[0:3] offset:0
  ds_write_b128 v252, v[4:7] offset:32
  s_nop 1
  v_mfma_f32_32x32x16_bf16 v[16:31], a[240:243], v[240:243], v[16:31]
  v_add_f32 v248, s55, v112
  v_rcp_f32 v248, v248
  s_nop 0
  v_mul_f32 v120, v248, v120
  v_mul_f32 v121, v248, v121
  s_waitcnt vmcnt(5)
  v_mfma_f32_32x32x16_bf16 v[96:111], v[160:163], a[36:39], 0
  v_mul_f32 v122, v248, v122
  v_mul_f32 v123, v248, v123
  v_mul_f32 v124, v248, v124
  v_mul_f32 v125, v248, v125
  v_mul_f32 v126, v248, v126
  v_mfma_f32_32x32x16_bf16 v[48:63], a[244:247], v[240:243], v[48:63]
  v_mul_f32 v127, v248, v127
  v_cvt_pk_bf16_f32 v244, v120, v121
  v_cvt_pk_bf16_f32 v245, v122, v123
  v_cvt_pk_bf16_f32 v246, v124, v125
  v_cvt_pk_bf16_f32 v247, v126, v127
  ds_write_b128 v252, v[8:11] offset:64
  ds_write_b128 v252, v[12:15] offset:96
  s_nop 1
  v_mfma_f32_32x32x16_bf16 v[16:31], a[248:251], v[244:247], v[16:31]
  v_add_f32 v248, s55, v96
  v_rcp_f32 v248, v248
  s_nop 0
  v_mul_f32 v104, v248, v104
  v_mul_f32 v105, v248, v105
  s_waitcnt vmcnt(4)
  v_mfma_f32_32x32x16_bf16 v[112:127], v[168:171], a[44:47], 0
  v_mul_f32 v106, v248, v106
  v_mul_f32 v107, v248, v107
  v_mul_f32 v108, v248, v108
  v_mul_f32 v109, v248, v109
  v_mul_f32 v110, v248, v110
  v_mfma_f32_32x32x16_bf16 v[48:63], a[252:255], v[244:247], v[48:63]
  v_mul_f32 v111, v248, v111
  v_cvt_pk_bf16_f32 v240, v104, v105
  v_cvt_pk_bf16_f32 v241, v106, v107
  v_cvt_pk_bf16_f32 v242, v108, v109
  v_cvt_pk_bf16_f32 v243, v110, v111
  ds_write_b128 v252, v[32:35] offset:128
  ds_write_b128 v252, v[36:39] offset:160
  s_nop 1
  v_mfma_f32_32x32x16_bf16 v[16:31], v[192:195], v[240:243], v[16:31]
  v_add_f32 v248, s55, v112
  v_rcp_f32 v248, v248
  s_nop 0
  v_mul_f32 v120, v248, v120
  v_mul_f32 v121, v248, v121
  s_waitcnt vmcnt(3)
  v_mfma_f32_32x32x16_bf16 v[96:111], v[176:179], a[52:55], 0
  v_mul_f32 v122, v248, v122
  v_mul_f32 v123, v248, v123
  v_mul_f32 v124, v248, v124
  v_mul_f32 v125, v248, v125
  v_mul_f32 v126, v248, v126
  v_mfma_f32_32x32x16_bf16 v[48:63], v[196:199], v[240:243], v[48:63]
  v_mul_f32 v127, v248, v127
  v_cvt_pk_bf16_f32 v244, v120, v121
  v_cvt_pk_bf16_f32 v245, v122, v123
  v_cvt_pk_bf16_f32 v246, v124, v125
  v_cvt_pk_bf16_f32 v247, v126, v127
  ds_write_b128 v252, v[40:43] offset:192
  ds_write_b128 v252, v[44:47] offset:224
  s_nop 1
  v_mfma_f32_32x32x16_bf16 v[16:31], v[200:203], v[244:247], v[16:31]
  v_add_f32 v248, s55, v96
  v_rcp_f32 v248, v248
  s_nop 0
  v_mul_f32 v104, v248, v104
  v_mul_f32 v105, v248, v105
  s_waitcnt vmcnt(2)
  v_mfma_f32_32x32x16_bf16 v[112:127], v[184:187], a[60:63], 0
  v_mul_f32 v106, v248, v106
  v_mul_f32 v107, v248, v107
  v_mul_f32 v108, v248, v108
  v_mul_f32 v109, v248, v109
  v_mul_f32 v110, v248, v110
  v_mfma_f32_32x32x16_bf16 v[48:63], v[204:207], v[244:247], v[48:63]
  v_mul_f32 v111, v248, v111
  v_cvt_pk_bf16_f32 v240, v104, v105
  v_cvt_pk_bf16_f32 v241, v106, v107
  v_cvt_pk_bf16_f32 v242, v108, v109
  v_cvt_pk_bf16_f32 v243, v110, v111
  s_nop 1
  v_mfma_f32_32x32x16_bf16 v[16:31], v[208:211], v[240:243], v[16:31]
  v_add_f32 v248, s55, v112
  v_rcp_f32 v248, v248
  s_nop 0
  v_mul_f32 v120, v248, v120
  v_mul_f32 v121, v248, v121
  v_mul_f32 v122, v248, v122
  v_mul_f32 v123, v248, v123
  v_mul_f32 v124, v248, v124
  v_mul_f32 v125, v248, v125
  v_mul_f32 v126, v248, v126
  v_mfma_f32_32x32x16_bf16 v[48:63], v[212:215], v[240:243], v[48:63]
  v_mul_f32 v127, v248, v127
  v_cvt_pk_bf16_f32 v244, v120, v121
  v_cvt_pk_bf16_f32 v245, v122, v123
  v_cvt_pk_bf16_f32 v246, v124, v125
  v_cvt_pk_bf16_f32 v247, v126, v127
  s_nop 1
  v_mfma_f32_32x32x16_bf16 v[16:31], v[216:219], v[244:247], v[16:31]
  v_mfma_f32_32x32x16_bf16 v[48:63], v[220:223], v[244:247], v[48:63]
  v_lshrrev_b32 v242, 3, v238
  v_and_b32 v243, 7, v238
  v_mul_u32_u24 v246, 272, v242
  v_lshlrev_b32 v247, 5, v243
  v_add_u32 v246, v246, v247
  s_nop 7
  s_nop 1
  ds_write_b128 v252, v[16:19] offset:8704
  ds_write_b128 v252, v[20:23] offset:8736
  ds_write_b128 v252, v[24:27] offset:8768
  ds_write_b128 v252, v[28:31] offset:8800
  ds_write_b128 v252, v[48:51] offset:8832
  ds_write_b128 v252, v[52:55] offset:8864
  ds_write_b128 v252, v[56:59] offset:8896
  ds_write_b128 v252, v[60:63] offset:8928
  s_waitcnt lgkmcnt(0)
  s_barrier
  ds_read_b128 v[72:75], v246 offset:0
  ds_read_b128 v[76:79], v246 offset:16
  ds_read_b128 v[80:83], v246 offset:17408
  ds_read_b128 v[84:87], v246 offset:17424
  ds_read_b128 v[88:91], v246 offset:34816
  ds_read_b128 v[92:95], v246 offset:34832
  ds_read_b128 v[96:99], v246 offset:52224
  ds_read_b128 v[100:103], v246 offset:52240
  ds_read_b128 v[112:115], v246 offset:8704
  ds_read_b128 v[116:119], v246 offset:8720
  ds_read_b128 v[120:123], v246 offset:26112
  ds_read_b128 v[124:127], v246 offset:26128
  ds_read_b128 v[128:131], v246 offset:43520
  ds_read_b128 v[132:135], v246 offset:43536
  ds_read_b128 v[136:139], v246 offset:60928
  ds_read_b128 v[140:143], v246 offset:60944
  s_waitcnt lgkmcnt(8)
  v_pk_add_f32 v[72:73], v[72:73], v[80:81]
  v_pk_add_f32 v[88:89], v[88:89], v[96:97]
  v_pk_add_f32 v[74:75], v[74:75], v[82:83]
  v_pk_add_f32 v[90:91], v[90:91], v[98:99]
  v_pk_add_f32 v[76:77], v[76:77], v[84:85]
  v_pk_add_f32 v[92:93], v[92:93], v[100:101]
  v_pk_add_f32 v[78:79], v[78:79], v[86:87]
  v_pk_add_f32 v[94:95], v[94:95], v[102:103]
  v_pk_add_f32 v[72:73], v[72:73], v[88:89]
  v_pk_add_f32 v[74:75], v[74:75], v[90:91]
  v_pk_add_f32 v[76:77], v[76:77], v[92:93]
  v_pk_add_f32 v[78:79], v[78:79], v[94:95]
  s_waitcnt vmcnt(1)
  v_lshlrev_b32 v248, 16, v64
  v_and_b32 v249, 0xffff0000, v64
  v_pk_add_f32 v[72:73], v[72:73], v[248:249]
  v_cvt_pk_bf16_f32 v104, v72, v73
  v_lshlrev_b32 v248, 16, v65
  v_and_b32 v249, 0xffff0000, v65
  v_pk_add_f32 v[74:75], v[74:75], v[248:249]
  v_cvt_pk_bf16_f32 v105, v74, v75
  v_lshlrev_b32 v248, 16, v66
  v_and_b32 v249, 0xffff0000, v66
  v_pk_add_f32 v[76:77], v[76:77], v[248:249]
  v_cvt_pk_bf16_f32 v106, v76, v77
  v_lshlrev_b32 v248, 16, v67
  v_and_b32 v249, 0xffff0000, v67
  v_pk_add_f32 v[78:79], v[78:79], v[248:249]
  v_cvt_pk_bf16_f32 v107, v78, v79
  buffer_store_dwordx4 v[104:107], v250, s[12:15], s54 offen
  s_waitcnt lgkmcnt(0)
  v_pk_add_f32 v[112:113], v[112:113], v[120:121]
  v_pk_add_f32 v[128:129], v[128:129], v[136:137]
  v_pk_add_f32 v[114:115], v[114:115], v[122:123]
  v_pk_add_f32 v[130:131], v[130:131], v[138:139]
  v_pk_add_f32 v[116:117], v[116:117], v[124:125]
  v_pk_add_f32 v[132:133], v[132:133], v[140:141]
  v_pk_add_f32 v[118:119], v[118:119], v[126:127]
  v_pk_add_f32 v[134:135], v[134:135], v[142:143]
  v_pk_add_f32 v[112:113], v[112:113], v[128:129]
  v_pk_add_f32 v[114:115], v[114:115], v[130:131]
  v_pk_add_f32 v[116:117], v[116:117], v[132:133]
  v_pk_add_f32 v[118:119], v[118:119], v[134:135]
  s_waitcnt vmcnt(1)
  v_lshlrev_b32 v248, 16, v68
  v_and_b32 v249, 0xffff0000, v68
  v_pk_add_f32 v[112:113], v[112:113], v[248:249]
  v_cvt_pk_bf16_f32 v144, v112, v113
  v_lshlrev_b32 v248, 16, v69
  v_and_b32 v249, 0xffff0000, v69
  v_pk_add_f32 v[114:115], v[114:115], v[248:249]
  v_cvt_pk_bf16_f32 v145, v114, v115
  v_lshlrev_b32 v248, 16, v70
  v_and_b32 v249, 0xffff0000, v70
  v_pk_add_f32 v[116:117], v[116:117], v[248:249]
  v_cvt_pk_bf16_f32 v146, v116, v117
  v_lshlrev_b32 v248, 16, v71
  v_and_b32 v249, 0xffff0000, v71
  v_pk_add_f32 v[118:119], v[118:119], v[248:249]
  v_cvt_pk_bf16_f32 v147, v118, v119
  buffer_store_dwordx4 v[144:147], v250, s[12:15], s56 offen
K12_end:
  s_endpgm
.section .rodata,"a"
.p2align 6
.amdhsa_kernel parallel_sum__linear_attn_block__glu_gated_bilinear__prompt_kernel
  .amdhsa_next_free_vgpr 512
  .amdhsa_next_free_sgpr 102
  .amdhsa_accum_offset 256
  .amdhsa_group_segment_fixed_size 0
  .amdhsa_kernarg_size 80
  .amdhsa_user_sgpr_count 2
  .amdhsa_user_sgpr_kernarg_segment_ptr 1
  .amdhsa_system_sgpr_workgroup_id_x 1
.end_amdhsa_kernel
```
